```python
import torch

def _softmax(x, axis=-1):
    return torch.softmax(x, dim=axis)
def _gelu(x):
    return torch.nn.functional.gelu(x, approximate="tanh")
def _silu(x):
    return torch.nn.functional.silu(x)
def _sigmoid(x):
    return torch.sigmoid(x)
def _layernorm(x, axis=-1, eps=1e-5):
    m = x.mean(dim=axis, keepdim=True)
    v = x.var(dim=axis, keepdim=True, unbiased=False)
    return (x - m) / torch.sqrt(v + eps)
def _scatter_add(tgt, idx, src, axis=0):
    return tgt.clone().index_add_(axis, idx, src)
def _segment_sum(src, seg, n):
    out = torch.zeros((n,) + src.shape[1:], dtype=src.dtype)
    return out.index_add_(0, seg, src)
def _pad(x, pw):
    flat = tuple(v for pair in reversed(pw) for v in pair)
    return torch.nn.functional.pad(x, flat)

kernel_name = 'sequential_preLN__softmax_full_mha__glu_gated_reglu__prompt'

def setup_inputs():

    _w = (lambda a: (lambda t: t.to(torch.bfloat16) if t.is_floating_point() else t)(torch.as_tensor(a)))
    def _A_setup():
        B, S, D = 1, 2048, 448
        return {
            "x": _w((lambda *s: torch.randn(*s, dtype=torch.bfloat16) * 0.05)(B, S, D)),
            "wqkv": _w((lambda *s: torch.randn(*s, dtype=torch.bfloat16) * 0.05)(D, 3 * D)),
            "wo": _w((lambda *s: torch.randn(*s, dtype=torch.bfloat16) * 0.05)(D, D)),
        }
    _A_in = _A_setup()

    def _B_setup():
        B, S, D, F = 1, 2048, 448, 1792
        return {
            "x": _w((lambda *s: torch.randn(*s, dtype=torch.bfloat16) * 0.05)(B, S, D)),
            "W_gate": _w((lambda *s: torch.randn(*s, dtype=torch.bfloat16) * 0.4)(D, F) * (2.0 / D) ** 0.5),
            "W_up": _w((lambda *s: torch.randn(*s, dtype=torch.bfloat16) * 0.4)(D, F) * (2.0 / D) ** 0.5),
            "W_down": _w((lambda *s: torch.randn(*s, dtype=torch.bfloat16) * 0.4)(F, D) * (1.0 / F) ** 0.5),
        }
    _B_in = _B_setup()

    return {
        "A_x": _A_in["x"],
        "A_wqkv": _A_in["wqkv"],
        "A_wo": _A_in["wo"],
        "B_x": _B_in["x"],
        "B_W_gate": _B_in["W_gate"],
        "B_W_up": _B_in["W_up"],
        "B_W_down": _B_in["W_down"],
    }

def reference(A_x, A_wqkv, A_wo, B_x, B_W_gate, B_W_up, B_W_down):
    def _A_ref(x, wqkv, wo):
        B, S, D = x.shape
        H = 16; Dh = D // H
        qkv = (lambda x, *d: x.permute(*d))((x @ wqkv).reshape(B, S, 3, H, Dh), 2, 0, 3, 1, 4)
        q, k, v = qkv[0], qkv[1], qkv[2]
        scale = Dh ** -0.5
        scores = torch.einsum("bhqd,bhkd->bhqk", q, k) * scale
        p = _softmax(scores, axis=-1)
        o = torch.einsum("bhqk,bhkd->bhqd", p, v)
        return (lambda x, *d: x.permute(*d))(o, 0, 2, 1, 3).reshape(B, S, D) @ wo

    def _B_ref(x, W_gate, W_up, W_down):
        gate = torch.einsum("bsd,df->bsf", x, W_gate)
        up = torch.einsum("bsd,df->bsf", x, W_up)
        gate = gate * (lambda x, dt: x.to(dt))(gate > 0, gate.dtype)
        h = gate * up
        return torch.einsum("bsf,fd->bsd", h, W_down)

    x = A_x
    h = x + _A_ref(_layernorm(x, axis=-1), A_wqkv, A_wo)
    h2 = h + _B_ref(_layernorm(h, axis=-1), B_W_gate, B_W_up, B_W_down)
    return h2
```

```asm
; @launch grid=(256,1,1) block=(512,1,1) lds=163840
.amdgcn_target "amdgcn-amd-amdhsa--gfx950"
.text
.globl sequential_preLN__softmax_full_mha__glu_gated_reglu__prompt_kernel
.p2align 8
.type sequential_preLN__softmax_full_mha__glu_gated_reglu__prompt_kernel,@function
sequential_preLN__softmax_full_mha__glu_gated_reglu__prompt_kernel:
    s_cmp_ge_u32 s2, 256
    s_cbranch_scc1 END_sequential_preLN__softmax_full_mha__glu_gated_reglu__prompt_kernel_1
    s_load_dwordx16 s[4:19], s[0:1], 0
    s_load_dwordx4 s[20:23], s[0:1], 64
    v_lshrrev_b32 v1, 6, v0
    s_mov_b32 s30, 0
    v_readfirstlane_b32 s28, v1
    v_and_b32 v1, 63, v0
    v_lshlrev_b32 v2, 4, v1
    s_mov_b32 s31, -1
    s_and_b32 s29, s28, 3
    s_bfe_u32 s47, s2, 0x20000
    s_lshl_b32 s47, s47, 2
    s_bfe_u32 s48, s2, 0x20003
    s_add_u32 s42, s47, s48
    s_bfe_u32 s47, s2, 0x10002
    s_lshl_b32 s47, s47, 3
    s_lshr_b32 s49, s2, 5
    s_add_u32 s43, s47, s49
    s_lshl_b32 s44, s42, 2
    s_add_u32 s44, s44, s29
    s_mov_b32 s53, 0
    s_mov_b32 s54, 0
    s_cmp_ge_u32 s28, 4
    s_cbranch_scc1 P1HE_sequential_preLN__softmax_full_mha__glu_gated_reglu__prompt_kernel_4
    s_cmp_lg_u32 s28, 1
    s_cbranch_scc1 CP_sequential_preLN__softmax_full_mha__glu_gated_reglu__prompt_kernel_6
    s_lshr_b32 s34, s2, 3
    s_cmp_ge_u32 s34, 10
    s_cbranch_scc1 CP_sequential_preLN__softmax_full_mha__glu_gated_reglu__prompt_kernel_6
    s_cmp_ge_u32 s34, 5
    s_cselect_b32 s35, 5, 0
    s_sub_u32 s34, s34, s35
    s_lshl_b32 s34, s34, 13
    v_lshlrev_b32 v6, 7, v1
    v_add_u32 v6, s34, v6
    s_getpc_b64 s[36:37]
CODE_REF:
    v_min_u32 v6, CODE_END-CODE_REF-4, v6
    v_mov_b32 v7, s37
    v_add_co_u32 v6, vcc, s36, v6
    s_nop 1
    v_addc_co_u32 v7, vcc, 0, v7, vcc
    global_load_dword v12, v[6:7], off
CP_sequential_preLN__softmax_full_mha__glu_gated_reglu__prompt_kernel_6:
    s_cmp_lg_u32 s28, 0
    s_cbranch_scc1 EP_sequential_preLN__softmax_full_mha__glu_gated_reglu__prompt_kernel_5
    v_and_b32 v6, 15, v1
    v_lshlrev_b32 v6, 2, v6
    v_add_u32 v6, 163776, v6
    v_mov_b32 v7, 0
    ds_write_b32 v6, v7
    s_cmp_lg_u32 s2, 0
    s_cbranch_scc1 EP_sequential_preLN__softmax_full_mha__glu_gated_reglu__prompt_kernel_5
    s_memrealtime s[32:33]
    s_waitcnt lgkmcnt(0)
    s_or_b32 s32, s32, 1
    v_mov_b32 v4, s32
    v_mov_b32 v5, s33
    v_mov_b32 v6, 0
    s_mov_b64 exec, 1
    global_store_dwordx2 v6, v[4:5], s[20:21] sc1
    s_mov_b64 exec, -1
EP_sequential_preLN__softmax_full_mha__glu_gated_reglu__prompt_kernel_5:
    s_lshl_b32 s92, s2, 2
    s_add_u32 s92, s92, s29
    v_lshlrev_b32 v22, 7, v1
    s_waitcnt lgkmcnt(0)
    s_mov_b32 s88, s4
    s_mov_b32 s89, s5
    s_mov_b32 s90, 1835008
    s_mov_b32 s91, 0x20000
    s_mul_i32 s48, s92, 1792
    s_mov_b64 exec, 0x3fff
    v_add_u32 v23, s48, v22
    buffer_load_dword v13, v23, s[88:91], 0 offen
    s_mov_b64 exec, -1
    s_mov_b32 s88, s6
    s_mov_b32 s89, s7
    s_mov_b32 s90, 1204224
    s_mov_b32 s91, 0x20000
    s_mul_i32 s48, s92, 1280
    s_mov_b64 exec, 0x3ff
    v_add_u32 v23, s48, v22
    buffer_load_dword v13, v23, s[88:91], 0 offen
    s_mov_b64 exec, -1
    s_mov_b32 s88, s22
    s_mov_b32 s89, s23
    s_mov_b32 s90, 24576000
    s_mov_b32 s91, 0x20000
    s_lshl_b32 s48, s92, 8
    s_add_u32 s48, s48, 23527424
    s_mov_b64 exec, 3
    buffer_load_dword v13, v22, s[88:91], s48 offen sc1
    s_mov_b64 exec, -1
    s_branch P1C_sequential_preLN__softmax_full_mha__glu_gated_reglu__prompt_kernel_2
P1HE_sequential_preLN__softmax_full_mha__glu_gated_reglu__prompt_kernel_4:
    s_setprio 2
    s_mul_i32 s46, s44, 28672
    v_lshrrev_b32 v16, 3, v1
    v_mul_u32_u24 v16, 896, v16
    v_add_u32 v16, s46, v16
    v_lshrrev_b32 v17, 4, v1
    v_and_b32 v18, 7, v1
    v_xor_b32 v17, v17, v18
    v_lshl_add_u32 v24, v17, 4, v16
    v_add_u32 v26, 12288, v24
    v_xor_b32 v17, 4, v17
    v_lshl_add_u32 v25, v17, 4, v16
    v_add_u32 v27, 18432, v25
    v_add_u32 v25, 6144, v25
    s_mul_i32 s46, s29, 43008
    s_mul_i32 s47, s43, 112
    s_add_u32 s46, s46, s47
    s_add_u32 s46, s46, 896
    v_bfe_u32 v17, v1, 4, 1
    v_lshlrev_b32 v17, 2, v17
    v_xor_b32 v18, v18, v17
    v_cmp_ne_u32 s[70:71], 7, v18
    v_lshrrev_b32 v16, 3, v1
    v_mul_u32_u24 v16, 2688, v16
    v_lshl_add_u32 v16, v18, 4, v16
    v_add_u32 v28, s46, v16
    v_add_u32 v29, 20480, v28
    s_lshl_b32 s66, s29, 12
    s_lshl_b32 s67, s29, 11
    s_add_u32 s67, s67, 16384
    s_mov_b32 s68, 0
    s_mov_b32 s64, 0
    s_mul_i32 s65, s64, 1344
    s_waitcnt lgkmcnt(0)
    s_mov_b32 s56, s4
    s_mov_b32 s57, s5
    s_mov_b32 s58, 1835008
    s_mov_b32 s59, 0x20000
    s_mov_b32 s60, s6
    s_mov_b32 s61, s7
    s_mov_b32 s62, 1204224
    s_mov_b32 s63, 0x20000
    s_add_u32 m0, s66, s68
    s_nop 0
    buffer_load_dwordx4 v24, s[56:59], s64 offen offset:0 lds
    buffer_load_dwordx4 v25, s[56:59], s64 offen offset:1024 lds
    buffer_load_dwordx4 v26, s[56:59], s64 offen offset:2048 lds
    buffer_load_dwordx4 v27, s[56:59], s64 offen offset:3072 lds
    s_add_u32 m0, s67, s68
    s_mov_b64 exec, s[70:71]
    buffer_load_dwordx4 v28, s[60:63], s65 offen offset:0 lds
    buffer_load_dwordx4 v29, s[60:63], s65 offen offset:1024 lds
    s_mov_b64 exec, -1
    s_add_u32 s64, s64, 128
    s_mul_i32 s65, s64, 1344
    s_add_u32 s68, s68, 24576
    s_cmp_eq_u32 s68, 49152
    s_cselect_b32 s68, 98304, s68
    s_cmp_eq_u32 s68, 147456
    s_cselect_b32 s68, 0, s68
    s_add_u32 m0, s66, s68
    s_nop 0
    buffer_load_dwordx4 v24, s[56:59], s64 offen offset:0 lds
    buffer_load_dwordx4 v25, s[56:59], s64 offen offset:1024 lds
    buffer_load_dwordx4 v26, s[56:59], s64 offen offset:2048 lds
    buffer_load_dwordx4 v27, s[56:59], s64 offen offset:3072 lds
    s_add_u32 m0, s67, s68
    s_mov_b64 exec, s[70:71]
    buffer_load_dwordx4 v28, s[60:63], s65 offen offset:0 lds
    buffer_load_dwordx4 v29, s[60:63], s65 offen offset:1024 lds
    s_mov_b64 exec, -1
    s_add_u32 s64, s64, 128
    s_mul_i32 s65, s64, 1344
    s_add_u32 s68, s68, 24576
    s_cmp_eq_u32 s68, 49152
    s_cselect_b32 s68, 98304, s68
    s_cmp_eq_u32 s68, 147456
    s_cselect_b32 s68, 0, s68
    s_mov_b32 s24, s22
    s_mov_b32 s25, s23
    s_mov_b32 s26, 24576000
    s_mov_b32 s27, 0x20000
    v_bfe_u32 v19, v1, 2, 2
    v_lshrrev_b32 v16, 5, v1
    v_lshl_add_u32 v19, v16, 3, v19
    v_lshlrev_b32 v19, 7, v19
    v_and_b32 v16, 1, v1
    v_lshl_add_u32 v19, v16, 5, v19
    v_bfe_u32 v16, v1, 1, 1
    v_lshl_add_u32 v19, v16, 3, v19
    v_bfe_u32 v16, v1, 4, 1
    v_lshl_add_u32 v19, v16, 4, v19
    v_add_u32 v20, 56, v19
    v_bfe_u32 v16, v1, 3, 1
    v_lshlrev_b32 v16, 6, v16
    v_xor_b32 v19, v19, v16
    v_add_u32 v19, 16384, v19
    v_xor_b32 v20, v20, v16
    v_add_u32 v20, 16384, v20
    v_bfe_u32 v21, v1, 2, 2
    v_lshrrev_b32 v16, 5, v1
    v_lshl_add_u32 v21, v16, 3, v21
    v_lshlrev_b32 v21, 6, v21
    v_and_b32 v16, 1, v1
    v_lshl_add_u32 v21, v16, 5, v21
    v_bfe_u32 v16, v1, 1, 1
    v_lshl_add_u32 v21, v16, 3, v21
    v_bfe_u32 v16, v1, 4, 1
    v_lshl_add_u32 v21, v16, 4, v21
    v_add_u32 v21, 65536, v21
    s_lshl_b32 s46, s29, 11
    v_add_u32 v19, s46, v19
    v_add_u32 v20, s46, v20
    v_lshrrev_b32 v16, 2, v1
    v_mul_u32_u24 v16, 2688, v16
    v_and_b32 v17, 3, v1
    v_lshl_add_u32 v30, v17, 4, v16
    v_mov_b32 v240, 0x3f803f80
    v_mov_b32 v241, 0x3f803f80
    v_mov_b32 v242, 0x3f803f80
    v_mov_b32 v243, 0x3f803f80
    v_mov_b32 v32, 0
    v_mov_b32 v33, 0
    v_mov_b32 v34, 0
    v_mov_b32 v35, 0
    v_mov_b32 v36, 0
    v_mov_b32 v37, 0
    v_mov_b32 v38, 0
    v_mov_b32 v39, 0
    v_mov_b32 v40, 0
    v_mov_b32 v41, 0
    v_mov_b32 v42, 0
    v_mov_b32 v43, 0
    v_mov_b32 v44, 0
    v_mov_b32 v45, 0
    v_mov_b32 v46, 0
    v_mov_b32 v47, 0
    v_mov_b32 v48, 0
    v_mov_b32 v49, 0
    v_mov_b32 v50, 0
    v_mov_b32 v51, 0
    v_mov_b32 v52, 0
    v_mov_b32 v53, 0
    v_mov_b32 v54, 0
    v_mov_b32 v55, 0
    v_mov_b32 v56, 0
    v_mov_b32 v57, 0
    v_mov_b32 v58, 0
    v_mov_b32 v59, 0
    v_mov_b32 v60, 0
    v_mov_b32 v61, 0
    v_mov_b32 v62, 0
    v_mov_b32 v63, 0
    s_lshl_b32 s84, s29, 13
    s_min_u32 s84, s84, 20480
    s_add_u32 s84, s84, 131200
    s_add_u32 s85, s84, 4096
    s_cmp_ge_u32 s29, 2
    s_cselect_b32 s85, 155776, s85
    s_cselect_b32 s86, 155776, s84
    s_lshl_b32 s38, s2, 1
    s_and_b32 s46, s29, 1
    s_add_u32 s38, s38, s46
    v_lshrrev_b32 v16, 3, v1
    v_and_b32 v17, 7, v1
    v_lshlrev_b32 v17, 4, v17
    s_cmp_ge_u32 s29, 2
    s_cbranch_scc1 P1PS_sequential_preLN__softmax_full_mha__glu_gated_reglu__prompt_kernel_7
    s_cmp_lt_u32 s38, 392
    s_cselect_b32 s74, 1, 0
    s_min_u32 s38, s38, 391
    s_mov_b32 s76, s12
    s_mov_b32 s77, s13
    s_mov_b32 s78, 1605632
    s_mov_b32 s79, 0x20000
    s_mov_b32 s80, s14
    s_mov_b32 s81, s15
    s_mov_b32 s82, 1605632
    s_mov_b32 s83, 0x20000
    s_mul_i32 s72, s38, 2341
    s_lshr_b32 s72, s72, 16
    s_mul_i32 s48, s72, 28
    s_sub_u32 s73, s38, s48
    v_mul_u32_u24 v244, 3584, v16
    s_mul_i32 s39, s72, 114688
    s_mov_b32 s40, 28672
    s_branch P1PS_sequential_preLN__softmax_full_mha__glu_gated_reglu__prompt_kernel_8
P1PS_sequential_preLN__softmax_full_mha__glu_gated_reglu__prompt_kernel_7:
    s_cmp_lt_u32 s38, 504
    s_cselect_b32 s74, 2, 0
    s_min_u32 s38, s38, 503
    s_mul_i32 s72, s38, 9363
    s_lshr_b32 s72, s72, 16
    s_mul_i32 s48, s72, 7
    s_sub_u32 s73, s38, s48
    s_cmp_lt_u32 s72, 16
    s_cselect_b32 s76, s8, s16
    s_cselect_b32 s77, s9, s17
    s_mov_b32 s78, 1605632
    s_cselect_b32 s78, 401408, s78
    s_mov_b32 s79, 0x20000
    s_cselect_b32 s80, s8, s16
    s_cselect_b32 s81, s9, s17
    s_mov_b32 s82, 1605632
    s_cselect_b32 s82, 401408, s82
    s_mov_b32 s83, 0x20000
    s_cselect_b32 s48, 0, 16
    s_cselect_b32 s49, 32, 112
    s_mov_b32 s50, 18022400
    s_cselect_b32 s50, 17563648, s50
    s_mov_b32 s51, 28672
    s_cselect_b32 s51, 25088, s51
    s_cselect_b32 s52, -1, 0
    s_sub_u32 s72, s72, s48
    v_mul_u32_u24 v244, 896, v16
    s_mul_i32 s39, s72, s51
    s_mov_b32 s40, 7168
P1PS_sequential_preLN__softmax_full_mha__glu_gated_reglu__prompt_kernel_8:
    v_add_u32 v244, v244, v17
    s_cmp_ge_u32 s29, 2
    s_cselect_b32 s48, 0x40000000, 0
    v_or_b32 v245, s48, v244
    s_lshl_b32 s48, s73, 7
    s_add_u32 s39, s39, s48
P1H_sequential_preLN__softmax_full_mha__glu_gated_reglu__prompt_kernel_9:
    v_add_u32 v16, s54, v19
    v_add_u32 v17, s54, v20
    s_waitcnt vmcnt(6)
    s_barrier
    ds_read_b64_tr_b16 v[204:205], v16 offset:0
    ds_read_b64_tr_b16 v[206:207], v16 offset:512
    ds_read_b64_tr_b16 v[208:209], v17 offset:0
    ds_read_b64_tr_b16 v[210:211], v17 offset:512
    s_add_u32 m0, s66, s68
    s_nop 0
    buffer_load_dwordx4 v24, s[56:59], s64 offen offset:0 lds
    buffer_load_dwordx4 v25, s[56:59], s64 offen offset:1024 lds
    buffer_load_dwordx4 v26, s[56:59], s64 offen offset:2048 lds
    buffer_load_dwordx4 v27, s[56:59], s64 offen offset:3072 lds
    s_add_u32 m0, s67, s68
    s_mov_b64 exec, s[70:71]
    buffer_load_dwordx4 v28, s[60:63], s65 offen offset:0 lds
    buffer_load_dwordx4 v29, s[60:63], s65 offen offset:1024 lds
    s_mov_b64 exec, -1
    s_add_u32 s64, s64, 128
    s_mul_i32 s65, s64, 1344
    s_add_u32 s68, s68, 24576
    s_cmp_eq_u32 s68, 49152
    s_cselect_b32 s68, 98304, s68
    s_cmp_eq_u32 s68, 147456
    s_cselect_b32 s68, 0, s68
    s_waitcnt lgkmcnt(0)
    v_mfma_f32_32x32x16_bf16 v[32:47], v[240:243], v[204:207], v[32:47]
    v_mfma_f32_32x32x16_bf16 v[48:63], v[240:243], v[208:211], v[48:63]
    s_add_u32 s54, s54, 24576
    s_cmp_eq_u32 s54, 49152
    s_cselect_b32 s54, 98304, s54
    s_cmp_eq_u32 s54, 147456
    s_cselect_b32 s54, 0, s54
    s_add_u32 s53, s53, 1
    s_cmp_lt_u32 s53, 5
    s_cbranch_scc1 P1H_sequential_preLN__softmax_full_mha__glu_gated_reglu__prompt_kernel_9
    v_add_u32 v16, s54, v19
    v_add_u32 v17, s54, v20
    s_waitcnt vmcnt(6)
    s_barrier
    ds_read_b64_tr_b16 v[204:205], v16 offset:0
    ds_read_b64_tr_b16 v[206:207], v16 offset:512
    ds_read_b64_tr_b16 v[208:209], v17 offset:0
    ds_read_b64_tr_b16 v[210:211], v17 offset:512
    s_mul_i32 s64, s29, 301056
    s_mul_i32 s65, s43, 56
    s_add_u32 s64, s64, s65
    s_mul_i32 s66, s29, 7168
    s_add_u32 m0, s66, 65536
    s_nop 0
    buffer_load_dwordx4 v30, s[60:63], s64 offen lds
    s_add_u32 s64, s64, 43008
    s_add_u32 m0, s66, 66560
    s_nop 0
    buffer_load_dwordx4 v30, s[60:63], s64 offen lds
    s_add_u32 s64, s64, 43008
    s_add_u32 m0, s66, 67584
    s_nop 0
    buffer_load_dwordx4 v30, s[60:63], s64 offen lds
    s_add_u32 s64, s64, 43008
    s_add_u32 m0, s66, 68608
    s_nop 0
    buffer_load_dwordx4 v30, s[60:63], s64 offen lds
    s_add_u32 s64, s64, 43008
    s_waitcnt lgkmcnt(0)
    v_mfma_f32_32x32x16_bf16 v[32:47], v[240:243], v[204:207], v[32:47]
    v_mfma_f32_32x32x16_bf16 v[48:63], v[240:243], v[208:211], v[48:63]
    s_add_u32 s54, s54, 24576
    s_cmp_eq_u32 s54, 49152
    s_cselect_b32 s54, 98304, s54
    s_cmp_eq_u32 s54, 147456
    s_cselect_b32 s54, 0, s54
    s_add_u32 s53, s53, 1
    v_add_u32 v16, s54, v19
    v_add_u32 v17, s54, v20
    s_waitcnt vmcnt(4)
    s_barrier
    ds_read_b64_tr_b16 v[204:205], v16 offset:0
    ds_read_b64_tr_b16 v[206:207], v16 offset:512
    ds_read_b64_tr_b16 v[208:209], v17 offset:0
    ds_read_b64_tr_b16 v[210:211], v17 offset:512
    s_add_u32 m0, s66, 69632
    s_nop 0
    buffer_load_dwordx4 v30, s[60:63], s64 offen lds
    s_add_u32 s64, s64, 43008
    s_add_u32 m0, s66, 70656
    s_nop 0
    buffer_load_dwordx4 v30, s[60:63], s64 offen lds
    s_add_u32 s64, s64, 43008
    s_add_u32 m0, s66, 71680
    s_nop 0
    buffer_load_dwordx4 v30, s[60:63], s64 offen lds
    s_waitcnt lgkmcnt(0)
    v_mfma_f32_32x32x16_bf16 v[32:47], v[240:243], v[204:207], v[32:47]
    v_mfma_f32_32x32x16_bf16 v[48:63], v[240:243], v[208:211], v[48:63]
    s_add_u32 s54, s54, 24576
    s_cmp_eq_u32 s54, 49152
    s_cselect_b32 s54, 98304, s54
    s_cmp_eq_u32 s54, 147456
    s_cselect_b32 s54, 0, s54
    s_add_u32 s53, s53, 1
    s_lshl_b32 s46, s29, 2
    s_add_u32 s46, s46, 94208
    v_add_u32 v16, s46, v2
    v_add_u32 v17, s66, v21
    s_nop 4
    ds_write_b32 v16, v32 offset:0
    ds_write_b32 v16, v48 offset:1024
    s_waitcnt lgkmcnt(0)
    s_barrier
    s_setprio 0
    v_mov_b32 v6, 0
    global_load_dwordx2 v[4:5], v6, s[20:21] sc1
    s_waitcnt vmcnt(1)
    s_barrier
    s_mov_b32 s34, 0
GE_sequential_preLN__softmax_full_mha__glu_gated_reglu__prompt_kernel_10:
    s_waitcnt vmcnt(0)
    v_cmp_eq_u32 vcc, 0, v4
    s_add_u32 s34, s34, 1
    s_cmp_gt_u32 s34, 65536
    s_cbranch_vccz GE_sequential_preLN__softmax_full_mha__glu_gated_reglu__prompt_kernel_11
    s_cbranch_scc1 GE_sequential_preLN__softmax_full_mha__glu_gated_reglu__prompt_kernel_11
    v_mov_b32 v6, 0
    global_load_dwordx2 v[4:5], v6, s[20:21] sc1
    s_branch GE_sequential_preLN__softmax_full_mha__glu_gated_reglu__prompt_kernel_10
GE_sequential_preLN__softmax_full_mha__glu_gated_reglu__prompt_kernel_11:
    s_cmp_lt_u32 s29, 2
    s_cbranch_scc1 PBD_sequential_preLN__softmax_full_mha__glu_gated_reglu__prompt_kernel_12
    s_add_u32 m0, s84, 0
    s_nop 0
    buffer_load_dwordx4 v244, s[76:79], s39 offen lds
    s_add_u32 s39, s39, s40
    s_add_u32 m0, s84, 1024
    s_nop 0
    buffer_load_dwordx4 v244, s[76:79], s39 offen lds
    s_add_u32 s39, s39, s40
    s_add_u32 m0, s84, 2048
    s_nop 0
    buffer_load_dwordx4 v244, s[76:79], s39 offen lds
    s_add_u32 s39, s39, s40
    s_add_u32 m0, s84, 3072
    s_nop 0
    buffer_load_dwordx4 v244, s[76:79], s39 offen lds
    s_add_u32 s39, s39, s40
    s_mov_b32 s39, 0
    s_mov_b32 s40, 0
PBD_sequential_preLN__softmax_full_mha__glu_gated_reglu__prompt_kernel_12:
    ds_read_b64_tr_b16 v[204:205], v17 offset:0
    ds_read_b64_tr_b16 v[206:207], v17 offset:256
    ds_read_b64_tr_b16 v[208:209], v17 offset:1024
    ds_read_b64_tr_b16 v[210:211], v17 offset:1280
    ds_read_b64_tr_b16 v[212:213], v17 offset:2048
    ds_read_b64_tr_b16 v[214:215], v17 offset:2304
    ds_read_b64_tr_b16 v[216:217], v17 offset:3072
    ds_read_b64_tr_b16 v[218:219], v17 offset:3328
    ds_read_b64_tr_b16 v[220:221], v17 offset:4096
    ds_read_b64_tr_b16 v[222:223], v17 offset:4352
    ds_read_b64_tr_b16 v[224:225], v17 offset:5120
    ds_read_b64_tr_b16 v[226:227], v17 offset:5376
    ds_read_b64_tr_b16 v[228:229], v17 offset:6144
    ds_read_b64_tr_b16 v[230:231], v17 offset:6400
    s_waitcnt lgkmcnt(12)
    v_mfma_f32_32x32x16_bf16 v[64:79], v[240:243], v[204:207], 0
    s_waitcnt lgkmcnt(10)
    v_mfma_f32_32x32x16_bf16 v[64:79], v[240:243], v[208:211], v[64:79]
    s_waitcnt lgkmcnt(8)
    v_mfma_f32_32x32x16_bf16 v[64:79], v[240:243], v[212:215], v[64:79]
    s_waitcnt lgkmcnt(6)
    v_mfma_f32_32x32x16_bf16 v[64:79], v[240:243], v[216:219], v[64:79]
    s_waitcnt lgkmcnt(4)
    v_mfma_f32_32x32x16_bf16 v[64:79], v[240:243], v[220:223], v[64:79]
    s_waitcnt lgkmcnt(2)
    v_mfma_f32_32x32x16_bf16 v[64:79], v[240:243], v[224:227], v[64:79]
    s_waitcnt lgkmcnt(0)
    v_mfma_f32_32x32x16_bf16 v[64:79], v[240:243], v[228:231], v[64:79]
    s_nop 11
    ds_write_b32 v16, v64 offset:2048
    s_waitcnt lgkmcnt(0)
    s_barrier
    s_cmp_lg_u32 s28, 4
    s_cbranch_scc1 W2_sequential_preLN__softmax_full_mha__glu_gated_reglu__prompt_kernel_13
    s_lshl_b32 s35, s42, 4
    s_add_u32 s35, s35, s43
    s_lshl_b32 s35, s35, 8
    s_add_u32 s35, s35, 23527424
    s_lshl_b32 s37, s43, 17
    v_lshlrev_b32 v6, 3, v1
    s_mov_b32 s34, 0
    s_mov_b64 exec, 0xffffffff
PL_sequential_preLN__softmax_full_mha__glu_gated_reglu__prompt_kernel_14:
    buffer_load_dwordx2 v[8:9], v6, s[24:27], s35 offen sc1
    s_add_u32 s34, s34, 1
    s_cmp_gt_u32 s34, 65536
    s_cbranch_scc1 PL_sequential_preLN__softmax_full_mha__glu_gated_reglu__prompt_kernel_15
    s_waitcnt vmcnt(0)
    v_cmp_ne_u64 vcc, v[8:9], v[4:5]
    s_nop 1
    s_cbranch_vccnz PL_sequential_preLN__softmax_full_mha__glu_gated_reglu__prompt_kernel_14
PL_sequential_preLN__softmax_full_mha__glu_gated_reglu__prompt_kernel_15:
    s_mov_b64 exec, -1
    s_mov_b32 m0, 0
    s_add_u32 s36, s37, 2097152
    buffer_load_dwordx4 v2, s[24:27], s36 offen offset:0 sc1 lds
    buffer_load_dwordx4 v2, s[24:27], s36 offen offset:1024 sc1 lds
    s_mov_b32 m0, 4096
    s_add_u32 s36, s37, 2099200
    buffer_load_dwordx4 v2, s[24:27], s36 offen offset:0 sc1 lds
    buffer_load_dwordx4 v2, s[24:27], s36 offen offset:1024 sc1 lds
    s_mov_b32 m0, 8192
    s_add_u32 s36, s37, 2129920
    buffer_load_dwordx4 v2, s[24:27], s36 offen offset:0 sc1 lds
    buffer_load_dwordx4 v2, s[24:27], s36 offen offset:1024 sc1 lds
    s_mov_b32 m0, 12288
    s_add_u32 s36, s37, 2131968
    buffer_load_dwordx4 v2, s[24:27], s36 offen offset:0 sc1 lds
    buffer_load_dwordx4 v2, s[24:27], s36 offen offset:1024 sc1 lds
    s_mov_b32 m0, 16384
    s_add_u32 s36, s37, 2162688
    buffer_load_dwordx4 v2, s[24:27], s36 offen offset:0 sc1 lds
    buffer_load_dwordx4 v2, s[24:27], s36 offen offset:1024 sc1 lds
    s_mov_b32 m0, 20480
    s_add_u32 s36, s37, 2164736
    buffer_load_dwordx4 v2, s[24:27], s36 offen offset:0 sc1 lds
    buffer_load_dwordx4 v2, s[24:27], s36 offen offset:1024 sc1 lds
    s_mov_b32 m0, 24576
    s_add_u32 s36, s37, 2195456
    buffer_load_dwordx4 v2, s[24:27], s36 offen offset:0 sc1 lds
    buffer_load_dwordx4 v2, s[24:27], s36 offen offset:1024 sc1 lds
    s_mov_b32 m0, 28672
    s_add_u32 s36, s37, 2197504
    buffer_load_dwordx4 v2, s[24:27], s36 offen offset:0 sc1 lds
    buffer_load_dwordx4 v2, s[24:27], s36 offen offset:1024 sc1 lds
    s_mov_b32 m0, 0
    s_add_u32 s36, s37, 4192256
    buffer_load_dwordx4 v2, s[24:27], s36 offen offset:2048 sc1 lds
    buffer_load_dwordx4 v2, s[24:27], s36 offen offset:3072 sc1 lds
    s_mov_b32 m0, 4096
    s_add_u32 s36, s37, 4194304
    buffer_load_dwordx4 v2, s[24:27], s36 offen offset:2048 sc1 lds
    buffer_load_dwordx4 v2, s[24:27], s36 offen offset:3072 sc1 lds
    s_mov_b32 m0, 8192
    s_add_u32 s36, s37, 4225024
    buffer_load_dwordx4 v2, s[24:27], s36 offen offset:2048 sc1 lds
    buffer_load_dwordx4 v2, s[24:27], s36 offen offset:3072 sc1 lds
    s_mov_b32 m0, 12288
    s_add_u32 s36, s37, 4227072
    buffer_load_dwordx4 v2, s[24:27], s36 offen offset:2048 sc1 lds
    buffer_load_dwordx4 v2, s[24:27], s36 offen offset:3072 sc1 lds
    s_mov_b32 m0, 16384
    s_add_u32 s36, s37, 4257792
    buffer_load_dwordx4 v2, s[24:27], s36 offen offset:2048 sc1 lds
    buffer_load_dwordx4 v2, s[24:27], s36 offen offset:3072 sc1 lds
    s_mov_b32 m0, 20480
    s_add_u32 s36, s37, 4259840
    buffer_load_dwordx4 v2, s[24:27], s36 offen offset:2048 sc1 lds
    buffer_load_dwordx4 v2, s[24:27], s36 offen offset:3072 sc1 lds
    s_mov_b32 m0, 24576
    s_add_u32 s36, s37, 4290560
    buffer_load_dwordx4 v2, s[24:27], s36 offen offset:2048 sc1 lds
    buffer_load_dwordx4 v2, s[24:27], s36 offen offset:3072 sc1 lds
    s_mov_b32 m0, 28672
    s_add_u32 s36, s37, 4292608
    buffer_load_dwordx4 v2, s[24:27], s36 offen offset:2048 sc1 lds
    buffer_load_dwordx4 v2, s[24:27], s36 offen offset:3072 sc1 lds
W2_sequential_preLN__softmax_full_mha__glu_gated_reglu__prompt_kernel_13:
    s_cmp_ge_u32 s29, 2
    s_cbranch_scc1 P1PB_sequential_preLN__softmax_full_mha__glu_gated_reglu__prompt_kernel_16
    v_bfe_u32 v16, v1, 2, 2
    v_lshrrev_b32 v17, 5, v1
    v_lshl_add_u32 v16, v17, 3, v16
    v_lshlrev_b32 v16, 7, v16
    v_bfe_u32 v17, v1, 4, 1
    v_lshl_add_u32 v16, v17, 12, v16
    v_and_b32 v17, 1, v1
    v_lshl_add_u32 v16, v17, 5, v16
    v_bfe_u32 v17, v1, 1, 1
    v_lshl_add_u32 v16, v17, 3, v16
    v_add_u32 v239, s84, v16
    s_lshl_b32 s49, s72, 7
    s_add_u32 s49, s49, 28672
    s_lshl_b32 s72, s72, 11
    s_mul_i32 s73, s73, 122880
    s_add_u32 s51, s73, 19628032
    s_add_u32 s88, s51, s72
    s_add_u32 s92, s51, s49
    s_add_u32 s51, s73, 19658752
    s_add_u32 s89, s51, s72
    s_add_u32 s93, s51, s49
    s_add_u32 s51, s73, 19689472
    s_add_u32 s90, s51, s72
    s_add_u32 s94, s51, s49
    s_add_u32 s51, s73, 19720192
    s_add_u32 s91, s51, s72
    s_add_u32 s95, s51, s49
    s_cmp_lg_u32 s74, 0
    s_cselect_b32 s48, 0, 0x40000000
    v_mov_b32 v236, 0x40000000
    v_or_b32 v237, s48, v2
    v_lshl_or_b32 v238, v1, 2, s48
    s_branch P1PR_sequential_preLN__softmax_full_mha__glu_gated_reglu__prompt_kernel_17
P1PB_sequential_preLN__softmax_full_mha__glu_gated_reglu__prompt_kernel_16:
    v_bfe_u32 v16, v1, 2, 2
    v_lshrrev_b32 v17, 5, v1
    v_lshl_add_u32 v16, v17, 4, v16
    v_lshlrev_b32 v16, 7, v16
    v_and_b32 v17, 1, v1
    v_lshl_add_u32 v16, v17, 5, v16
    v_bfe_u32 v17, v1, 1, 1
    v_lshl_add_u32 v16, v17, 3, v16
    v_bfe_u32 v17, v1, 4, 1
    v_lshl_add_u32 v16, v17, 4, v16
    v_add_u32 v239, s84, v16
    s_lshl_b32 s73, s73, 1
    s_mul_i32 s73, s73, s49
    s_lshl_b32 s72, s72, 1
    s_add_u32 s73, s73, s72
    s_lshl_b32 s73, s73, 10
    s_add_u32 s88, s50, s73
    s_lshl_b32 s49, s49, 10
    s_add_u32 s89, s49, s88
    s_cmp_lg_u32 s74, 0
    s_cselect_b32 s48, 0, 0x40000000
    v_or_b32 v236, s48, v2
    v_mov_b32 v237, 0x40000000
    v_mov_b32 v238, 0x40000000
    s_mov_b32 s90, 0
    s_mov_b32 s91, 0
    s_mov_b32 s92, 0
    s_mov_b32 s93, 0
    s_mov_b32 s94, 0
    s_mov_b32 s95, 0
    s_mov_b32 s96, s52
P1PR_sequential_preLN__softmax_full_mha__glu_gated_reglu__prompt_kernel_17:
    s_branch P1J_sequential_preLN__softmax_full_mha__glu_gated_reglu__prompt_kernel_3
P1C_sequential_preLN__softmax_full_mha__glu_gated_reglu__prompt_kernel_2:
    v_mov_b32 v36, 0x3f803f80
    v_mov_b32 v37, 0x3f803f80
    v_bfe_u32 v16, v1, 1, 1
    v_lshlrev_b32 v16, 6, v16
    v_xor_b32 v16, 112, v16
    v_lshl_add_u32 v16, v1, 7, v16
    s_mul_i32 s46, s29, 24576
    s_cmp_ge_u32 s29, 2
    s_cselect_b32 s47, 49152, 0
    s_add_u32 s46, s46, s47
    v_add_u32 v16, s46, v16
    ds_write_b64 v16, v[36:37] offset:16384
    v_and_b32 v34, 31, v1
    v_lshrrev_b32 v35, 5, v1
    v_bfe_u32 v16, v1, 1, 3
    v_xor_b32 v16, v16, v35
    v_lshlrev_b32 v17, 7, v34
    s_lshl_b32 s46, s29, 12
    v_add_u32 v17, s46, v17
    v_xor_b32 v18, 0, v16
    v_lshl_add_u32 v24, v18, 4, v17
    v_add_u32 v28, 98304, v24
    v_xor_b32 v18, 2, v16
    v_lshl_add_u32 v25, v18, 4, v17
    v_add_u32 v29, 98304, v25
    v_xor_b32 v18, 4, v16
    v_lshl_add_u32 v26, v18, 4, v17
    v_add_u32 v30, 98304, v26
    v_xor_b32 v18, 6, v16
    v_lshl_add_u32 v27, v18, 4, v17
    v_add_u32 v31, 98304, v27
    v_bfe_u32 v19, v1, 2, 2
    v_lshrrev_b32 v16, 5, v1
    v_lshl_add_u32 v19, v16, 3, v19
    v_lshlrev_b32 v19, 7, v19
    v_and_b32 v16, 1, v1
    v_lshl_add_u32 v19, v16, 5, v19
    v_bfe_u32 v16, v1, 1, 1
    v_lshl_add_u32 v19, v16, 3, v19
    v_bfe_u32 v16, v1, 4, 1
    v_lshl_add_u32 v19, v16, 4, v19
    v_add_u32 v20, 56, v19
    v_bfe_u32 v16, v1, 3, 1
    v_lshlrev_b32 v16, 6, v16
    v_xor_b32 v19, v19, v16
    v_add_u32 v19, 16384, v19
    v_xor_b32 v20, v20, v16
    v_add_u32 v20, 16384, v20
    v_bfe_u32 v21, v1, 2, 2
    v_lshrrev_b32 v16, 5, v1
    v_lshl_add_u32 v21, v16, 3, v21
    v_lshlrev_b32 v21, 6, v21
    v_and_b32 v16, 1, v1
    v_lshl_add_u32 v21, v16, 5, v21
    v_bfe_u32 v16, v1, 1, 1
    v_lshl_add_u32 v21, v16, 3, v21
    v_bfe_u32 v16, v1, 4, 1
    v_lshl_add_u32 v21, v16, 4, v21
    v_add_u32 v21, 65536, v21
    v_add_u32 v32, 98304, v19
    v_add_u32 v33, 98304, v20
    v_mov_b32 v217, 0
    v_mov_b32 v218, 0
    s_mov_b32 s58, 0xffff0000
    v_lshlrev_b32 v16, 5, v34
    v_lshl_add_u32 v16, v35, 4, v16
    v_xor_b32 v17, 1152, v16
    v_add_u32 v18, 1024, v2
    s_cmp_lt_u32 s43, 8
    s_cselect_b64 s[56:57], -1, 0
    v_cndmask_b32 v221, v16, v2, s[56:57]
    v_cndmask_b32 v222, v17, v18, s[56:57]
    s_lshl_b32 s45, s44, 11
    s_lshl_b32 s59, s43, 18
    s_add_u32 s59, s59, s45
    s_add_u32 s59, s59, 2097152
    s_add_u32 s45, s59, 131072
    v_mov_b32 v38, 0x3f80
    v_add_u32 v223, 94208, v2
    s_lshl_b32 s46, s29, 11
    s_add_u32 s46, s46, 98304
    v_add_u32 v224, s46, v2
    s_waitcnt lgkmcnt(0)
    s_mov_b32 s24, s22
    s_mov_b32 s25, s23
    s_mov_b32 s26, 24576000
    s_mov_b32 s27, 0x20000
    s_barrier
    v_mov_b32 v6, 0
    global_load_dwordx2 v[4:5], v6, s[20:21] sc1
    ds_read_b128 v[72:75], v24 offset:0
    ds_read_b64_tr_b16 v[184:185], v19 offset:0
    ds_read_b64_tr_b16 v[186:187], v19 offset:512
    ds_read_b64_tr_b16 v[188:189], v20 offset:0
    ds_read_b64_tr_b16 v[190:191], v20 offset:512
    ds_read_b128 v[76:79], v25 offset:0
    ds_read_b64_tr_b16 v[192:193], v19 offset:2048
    ds_read_b64_tr_b16 v[194:195], v19 offset:2560
    ds_read_b64_tr_b16 v[196:197], v20 offset:2048
    ds_read_b64_tr_b16 v[198:199], v20 offset:2560
    s_waitcnt lgkmcnt(5)
    v_mfma_f32_32x32x16_bf16 v[40:55], v[184:187], v[72:75], 0
    ds_read_b128 v[80:83], v26 offset:0
    ds_read_b64_tr_b16 v[200:201], v19 offset:4096
    ds_read_b64_tr_b16 v[202:203], v19 offset:4608
    v_lshlrev_b32 v219, 16, v72
    v_and_b32 v220, s58, v72
    v_fmac_f32 v217, v219, v219
    v_fmac_f32 v218, v220, v220
    v_lshlrev_b32 v219, 16, v73
    v_and_b32 v220, s58, v73
    v_fmac_f32 v217, v219, v219
    v_fmac_f32 v218, v220, v220
    v_mfma_f32_32x32x16_bf16 v[56:71], v[188:191], v[72:75], 0
    ds_read_b64_tr_b16 v[204:205], v20 offset:4096
    ds_read_b64_tr_b16 v[206:207], v20 offset:4608
    v_lshlrev_b32 v219, 16, v74
    v_and_b32 v220, s58, v74
    v_fmac_f32 v217, v219, v219
    v_fmac_f32 v218, v220, v220
    v_lshlrev_b32 v219, 16, v75
    v_and_b32 v220, s58, v75
    v_fmac_f32 v217, v219, v219
    v_fmac_f32 v218, v220, v220
    s_waitcnt lgkmcnt(5)
    v_mfma_f32_32x32x16_bf16 v[40:55], v[192:195], v[76:79], v[40:55]
    ds_read_b128 v[84:87], v27 offset:0
    ds_read_b64_tr_b16 v[208:209], v19 offset:6144
    ds_read_b64_tr_b16 v[210:211], v19 offset:6656
    v_lshlrev_b32 v219, 16, v76
    v_and_b32 v220, s58, v76
    v_fmac_f32 v217, v219, v219
    v_fmac_f32 v218, v220, v220
    v_lshlrev_b32 v219, 16, v77
    v_and_b32 v220, s58, v77
    v_fmac_f32 v217, v219, v219
    v_fmac_f32 v218, v220, v220
    v_mfma_f32_32x32x16_bf16 v[56:71], v[196:199], v[76:79], v[56:71]
    ds_read_b64_tr_b16 v[212:213], v20 offset:6144
    ds_read_b64_tr_b16 v[214:215], v20 offset:6656
    v_lshlrev_b32 v219, 16, v78
    v_and_b32 v220, s58, v78
    v_fmac_f32 v217, v219, v219
    v_fmac_f32 v218, v220, v220
    v_lshlrev_b32 v219, 16, v79
    v_and_b32 v220, s58, v79
    v_fmac_f32 v217, v219, v219
    v_fmac_f32 v218, v220, v220
    s_barrier
    s_waitcnt lgkmcnt(5)
    v_mfma_f32_32x32x16_bf16 v[40:55], v[200:203], v[80:83], v[40:55]
    ds_read_b128 v[88:91], v24 offset:24576
    ds_read_b64_tr_b16 v[184:185], v19 offset:24576
    ds_read_b64_tr_b16 v[186:187], v19 offset:25088
    v_lshlrev_b32 v219, 16, v80
    v_and_b32 v220, s58, v80
    v_fmac_f32 v217, v219, v219
    v_fmac_f32 v218, v220, v220
    v_lshlrev_b32 v219, 16, v81
    v_and_b32 v220, s58, v81
    v_fmac_f32 v217, v219, v219
    v_fmac_f32 v218, v220, v220
    v_mfma_f32_32x32x16_bf16 v[56:71], v[204:207], v[80:83], v[56:71]
    ds_read_b64_tr_b16 v[188:189], v20 offset:24576
    ds_read_b64_tr_b16 v[190:191], v20 offset:25088
    v_lshlrev_b32 v219, 16, v82
    v_and_b32 v220, s58, v82
    v_fmac_f32 v217, v219, v219
    v_fmac_f32 v218, v220, v220
    v_lshlrev_b32 v219, 16, v83
    v_and_b32 v220, s58, v83
    v_fmac_f32 v217, v219, v219
    v_fmac_f32 v218, v220, v220
    s_waitcnt lgkmcnt(5)
    v_mfma_f32_32x32x16_bf16 v[40:55], v[208:211], v[84:87], v[40:55]
    ds_read_b128 v[92:95], v25 offset:24576
    ds_read_b64_tr_b16 v[192:193], v19 offset:26624
    ds_read_b64_tr_b16 v[194:195], v19 offset:27136
    v_lshlrev_b32 v219, 16, v84
    v_and_b32 v220, s58, v84
    v_fmac_f32 v217, v219, v219
    v_fmac_f32 v218, v220, v220
    v_lshlrev_b32 v219, 16, v85
    v_and_b32 v220, s58, v85
    v_fmac_f32 v217, v219, v219
    v_fmac_f32 v218, v220, v220
    v_mfma_f32_32x32x16_bf16 v[56:71], v[212:215], v[84:87], v[56:71]
    ds_read_b64_tr_b16 v[196:197], v20 offset:26624
    ds_read_b64_tr_b16 v[198:199], v20 offset:27136
    v_lshlrev_b32 v219, 16, v86
    v_and_b32 v220, s58, v86
    v_fmac_f32 v217, v219, v219
    v_fmac_f32 v218, v220, v220
    v_lshlrev_b32 v219, 16, v87
    v_and_b32 v220, s58, v87
    v_fmac_f32 v217, v219, v219
    v_fmac_f32 v218, v220, v220
    s_waitcnt lgkmcnt(5)
    v_mfma_f32_32x32x16_bf16 v[40:55], v[184:187], v[88:91], v[40:55]
    ds_read_b128 v[96:99], v26 offset:24576
    ds_read_b64_tr_b16 v[200:201], v19 offset:28672
    ds_read_b64_tr_b16 v[202:203], v19 offset:29184
    v_lshlrev_b32 v219, 16, v88
    v_and_b32 v220, s58, v88
    v_fmac_f32 v217, v219, v219
    v_fmac_f32 v218, v220, v220
    v_lshlrev_b32 v219, 16, v89
    v_and_b32 v220, s58, v89
    v_fmac_f32 v217, v219, v219
    v_fmac_f32 v218, v220, v220
    v_mfma_f32_32x32x16_bf16 v[56:71], v[188:191], v[88:91], v[56:71]
    ds_read_b64_tr_b16 v[204:205], v20 offset:28672
    ds_read_b64_tr_b16 v[206:207], v20 offset:29184
    v_lshlrev_b32 v219, 16, v90
    v_and_b32 v220, s58, v90
    v_fmac_f32 v217, v219, v219
    v_fmac_f32 v218, v220, v220
    v_lshlrev_b32 v219, 16, v91
    v_and_b32 v220, s58, v91
    v_fmac_f32 v217, v219, v219
    v_fmac_f32 v218, v220, v220
    s_waitcnt lgkmcnt(5)
    v_mfma_f32_32x32x16_bf16 v[40:55], v[192:195], v[92:95], v[40:55]
    ds_read_b128 v[100:103], v27 offset:24576
    ds_read_b64_tr_b16 v[208:209], v19 offset:30720
    ds_read_b64_tr_b16 v[210:211], v19 offset:31232
    v_lshlrev_b32 v219, 16, v92
    v_and_b32 v220, s58, v92
    v_fmac_f32 v217, v219, v219
    v_fmac_f32 v218, v220, v220
    v_lshlrev_b32 v219, 16, v93
    v_and_b32 v220, s58, v93
    v_fmac_f32 v217, v219, v219
    v_fmac_f32 v218, v220, v220
    v_mfma_f32_32x32x16_bf16 v[56:71], v[196:199], v[92:95], v[56:71]
    ds_read_b64_tr_b16 v[212:213], v20 offset:30720
    ds_read_b64_tr_b16 v[214:215], v20 offset:31232
    v_lshlrev_b32 v219, 16, v94
    v_and_b32 v220, s58, v94
    v_fmac_f32 v217, v219, v219
    v_fmac_f32 v218, v220, v220
    v_lshlrev_b32 v219, 16, v95
    v_and_b32 v220, s58, v95
    v_fmac_f32 v217, v219, v219
    v_fmac_f32 v218, v220, v220
    s_barrier
    s_waitcnt lgkmcnt(5)
    v_mfma_f32_32x32x16_bf16 v[40:55], v[200:203], v[96:99], v[40:55]
    ds_read_b128 v[104:107], v28 offset:0
    ds_read_b64_tr_b16 v[184:185], v32 offset:0
    ds_read_b64_tr_b16 v[186:187], v32 offset:512
    v_lshlrev_b32 v219, 16, v96
    v_and_b32 v220, s58, v96
    v_fmac_f32 v217, v219, v219
    v_fmac_f32 v218, v220, v220
    v_lshlrev_b32 v219, 16, v97
    v_and_b32 v220, s58, v97
    v_fmac_f32 v217, v219, v219
    v_fmac_f32 v218, v220, v220
    v_mfma_f32_32x32x16_bf16 v[56:71], v[204:207], v[96:99], v[56:71]
    ds_read_b64_tr_b16 v[188:189], v33 offset:0
    ds_read_b64_tr_b16 v[190:191], v33 offset:512
    v_lshlrev_b32 v219, 16, v98
    v_and_b32 v220, s58, v98
    v_fmac_f32 v217, v219, v219
    v_fmac_f32 v218, v220, v220
    v_lshlrev_b32 v219, 16, v99
    v_and_b32 v220, s58, v99
    v_fmac_f32 v217, v219, v219
    v_fmac_f32 v218, v220, v220
    s_waitcnt lgkmcnt(5)
    v_mfma_f32_32x32x16_bf16 v[40:55], v[208:211], v[100:103], v[40:55]
    ds_read_b128 v[108:111], v29 offset:0
    ds_read_b64_tr_b16 v[192:193], v32 offset:2048
    ds_read_b64_tr_b16 v[194:195], v32 offset:2560
    v_lshlrev_b32 v219, 16, v100
    v_and_b32 v220, s58, v100
    v_fmac_f32 v217, v219, v219
    v_fmac_f32 v218, v220, v220
    v_lshlrev_b32 v219, 16, v101
    v_and_b32 v220, s58, v101
    v_fmac_f32 v217, v219, v219
    v_fmac_f32 v218, v220, v220
    v_mfma_f32_32x32x16_bf16 v[56:71], v[212:215], v[100:103], v[56:71]
    ds_read_b64_tr_b16 v[196:197], v33 offset:2048
    ds_read_b64_tr_b16 v[198:199], v33 offset:2560
    v_lshlrev_b32 v219, 16, v102
    v_and_b32 v220, s58, v102
    v_fmac_f32 v217, v219, v219
    v_fmac_f32 v218, v220, v220
    v_lshlrev_b32 v219, 16, v103
    v_and_b32 v220, s58, v103
    v_fmac_f32 v217, v219, v219
    v_fmac_f32 v218, v220, v220
    s_waitcnt lgkmcnt(5)
    v_mfma_f32_32x32x16_bf16 v[40:55], v[184:187], v[104:107], v[40:55]
    ds_read_b128 v[112:115], v30 offset:0
    ds_read_b64_tr_b16 v[200:201], v32 offset:4096
    ds_read_b64_tr_b16 v[202:203], v32 offset:4608
    v_lshlrev_b32 v219, 16, v104
    v_and_b32 v220, s58, v104
    v_fmac_f32 v217, v219, v219
    v_fmac_f32 v218, v220, v220
    v_lshlrev_b32 v219, 16, v105
    v_and_b32 v220, s58, v105
    v_fmac_f32 v217, v219, v219
    v_fmac_f32 v218, v220, v220
    v_mfma_f32_32x32x16_bf16 v[56:71], v[188:191], v[104:107], v[56:71]
    ds_read_b64_tr_b16 v[204:205], v33 offset:4096
    ds_read_b64_tr_b16 v[206:207], v33 offset:4608
    v_lshlrev_b32 v219, 16, v106
    v_and_b32 v220, s58, v106
    v_fmac_f32 v217, v219, v219
    v_fmac_f32 v218, v220, v220
    v_lshlrev_b32 v219, 16, v107
    v_and_b32 v220, s58, v107
    v_fmac_f32 v217, v219, v219
    v_fmac_f32 v218, v220, v220
    s_waitcnt lgkmcnt(5)
    v_mfma_f32_32x32x16_bf16 v[40:55], v[192:195], v[108:111], v[40:55]
    ds_read_b128 v[116:119], v31 offset:0
    ds_read_b64_tr_b16 v[208:209], v32 offset:6144
    ds_read_b64_tr_b16 v[210:211], v32 offset:6656
    v_lshlrev_b32 v219, 16, v108
    v_and_b32 v220, s58, v108
    v_fmac_f32 v217, v219, v219
    v_fmac_f32 v218, v220, v220
    v_lshlrev_b32 v219, 16, v109
    v_and_b32 v220, s58, v109
    v_fmac_f32 v217, v219, v219
    v_fmac_f32 v218, v220, v220
    v_mfma_f32_32x32x16_bf16 v[56:71], v[196:199], v[108:111], v[56:71]
    ds_read_b64_tr_b16 v[212:213], v33 offset:6144
    ds_read_b64_tr_b16 v[214:215], v33 offset:6656
    v_lshlrev_b32 v219, 16, v110
    v_and_b32 v220, s58, v110
    v_fmac_f32 v217, v219, v219
    v_fmac_f32 v218, v220, v220
    v_lshlrev_b32 v219, 16, v111
    v_and_b32 v220, s58, v111
    v_fmac_f32 v217, v219, v219
    v_fmac_f32 v218, v220, v220
    s_barrier
    s_waitcnt lgkmcnt(5)
    v_mfma_f32_32x32x16_bf16 v[40:55], v[200:203], v[112:115], v[40:55]
    ds_read_b128 v[120:123], v28 offset:24576
    ds_read_b64_tr_b16 v[184:185], v32 offset:24576
    ds_read_b64_tr_b16 v[186:187], v32 offset:25088
    v_lshlrev_b32 v219, 16, v112
    v_and_b32 v220, s58, v112
    v_fmac_f32 v217, v219, v219
    v_fmac_f32 v218, v220, v220
    v_lshlrev_b32 v219, 16, v113
    v_and_b32 v220, s58, v113
    v_fmac_f32 v217, v219, v219
    v_fmac_f32 v218, v220, v220
    v_mfma_f32_32x32x16_bf16 v[56:71], v[204:207], v[112:115], v[56:71]
    ds_read_b64_tr_b16 v[188:189], v33 offset:24576
    ds_read_b64_tr_b16 v[190:191], v33 offset:25088
    v_lshlrev_b32 v219, 16, v114
    v_and_b32 v220, s58, v114
    v_fmac_f32 v217, v219, v219
    v_fmac_f32 v218, v220, v220
    v_lshlrev_b32 v219, 16, v115
    v_and_b32 v220, s58, v115
    v_fmac_f32 v217, v219, v219
    v_fmac_f32 v218, v220, v220
    s_waitcnt lgkmcnt(5)
    v_mfma_f32_32x32x16_bf16 v[40:55], v[208:211], v[116:119], v[40:55]
    ds_read_b128 v[124:127], v29 offset:24576
    ds_read_b64_tr_b16 v[192:193], v32 offset:26624
    ds_read_b64_tr_b16 v[194:195], v32 offset:27136
    v_lshlrev_b32 v219, 16, v116
    v_and_b32 v220, s58, v116
    v_fmac_f32 v217, v219, v219
    v_fmac_f32 v218, v220, v220
    v_lshlrev_b32 v219, 16, v117
    v_and_b32 v220, s58, v117
    v_fmac_f32 v217, v219, v219
    v_fmac_f32 v218, v220, v220
    v_mfma_f32_32x32x16_bf16 v[56:71], v[212:215], v[116:119], v[56:71]
    ds_read_b64_tr_b16 v[196:197], v33 offset:26624
    ds_read_b64_tr_b16 v[198:199], v33 offset:27136
    v_lshlrev_b32 v219, 16, v118
    v_and_b32 v220, s58, v118
    v_fmac_f32 v217, v219, v219
    v_fmac_f32 v218, v220, v220
    v_lshlrev_b32 v219, 16, v119
    v_and_b32 v220, s58, v119
    v_fmac_f32 v217, v219, v219
    v_fmac_f32 v218, v220, v220
    s_waitcnt lgkmcnt(5)
    v_mfma_f32_32x32x16_bf16 v[40:55], v[184:187], v[120:123], v[40:55]
    ds_read_b128 v[128:131], v30 offset:24576
    ds_read_b64_tr_b16 v[200:201], v32 offset:28672
    ds_read_b64_tr_b16 v[202:203], v32 offset:29184
    v_lshlrev_b32 v219, 16, v120
    v_and_b32 v220, s58, v120
    v_fmac_f32 v217, v219, v219
    v_fmac_f32 v218, v220, v220
    v_lshlrev_b32 v219, 16, v121
    v_and_b32 v220, s58, v121
    v_fmac_f32 v217, v219, v219
    v_fmac_f32 v218, v220, v220
    v_mfma_f32_32x32x16_bf16 v[56:71], v[188:191], v[120:123], v[56:71]
    ds_read_b64_tr_b16 v[204:205], v33 offset:28672
    ds_read_b64_tr_b16 v[206:207], v33 offset:29184
    v_lshlrev_b32 v219, 16, v122
    v_and_b32 v220, s58, v122
    v_fmac_f32 v217, v219, v219
    v_fmac_f32 v218, v220, v220
    v_lshlrev_b32 v219, 16, v123
    v_and_b32 v220, s58, v123
    v_fmac_f32 v217, v219, v219
    v_fmac_f32 v218, v220, v220
    s_waitcnt lgkmcnt(5)
    v_mfma_f32_32x32x16_bf16 v[40:55], v[192:195], v[124:127], v[40:55]
    ds_read_b128 v[132:135], v31 offset:24576
    ds_read_b64_tr_b16 v[208:209], v32 offset:30720
    ds_read_b64_tr_b16 v[210:211], v32 offset:31232
    v_lshlrev_b32 v219, 16, v124
    v_and_b32 v220, s58, v124
    v_fmac_f32 v217, v219, v219
    v_fmac_f32 v218, v220, v220
    v_lshlrev_b32 v219, 16, v125
    v_and_b32 v220, s58, v125
    v_fmac_f32 v217, v219, v219
    v_fmac_f32 v218, v220, v220
    v_mfma_f32_32x32x16_bf16 v[56:71], v[196:199], v[124:127], v[56:71]
    ds_read_b64_tr_b16 v[212:213], v33 offset:30720
    ds_read_b64_tr_b16 v[214:215], v33 offset:31232
    v_lshlrev_b32 v219, 16, v126
    v_and_b32 v220, s58, v126
    v_fmac_f32 v217, v219, v219
    v_fmac_f32 v218, v220, v220
    v_lshlrev_b32 v219, 16, v127
    v_and_b32 v220, s58, v127
    v_fmac_f32 v217, v219, v219
    v_fmac_f32 v218, v220, v220
    s_barrier
    s_waitcnt lgkmcnt(5)
    v_mfma_f32_32x32x16_bf16 v[40:55], v[200:203], v[128:131], v[40:55]
    ds_read_b128 v[136:139], v24 offset:0
    ds_read_b64_tr_b16 v[184:185], v19 offset:0
    ds_read_b64_tr_b16 v[186:187], v19 offset:512
    v_lshlrev_b32 v219, 16, v128
    v_and_b32 v220, s58, v128
    v_fmac_f32 v217, v219, v219
    v_fmac_f32 v218, v220, v220
    v_lshlrev_b32 v219, 16, v129
    v_and_b32 v220, s58, v129
    v_fmac_f32 v217, v219, v219
    v_fmac_f32 v218, v220, v220
    v_mfma_f32_32x32x16_bf16 v[56:71], v[204:207], v[128:131], v[56:71]
    ds_read_b64_tr_b16 v[188:189], v20 offset:0
    ds_read_b64_tr_b16 v[190:191], v20 offset:512
    v_lshlrev_b32 v219, 16, v130
    v_and_b32 v220, s58, v130
    v_fmac_f32 v217, v219, v219
    v_fmac_f32 v218, v220, v220
    v_lshlrev_b32 v219, 16, v131
    v_and_b32 v220, s58, v131
    v_fmac_f32 v217, v219, v219
    v_fmac_f32 v218, v220, v220
    s_waitcnt lgkmcnt(5)
    v_mfma_f32_32x32x16_bf16 v[40:55], v[208:211], v[132:135], v[40:55]
    ds_read_b128 v[140:143], v25 offset:0
    ds_read_b64_tr_b16 v[192:193], v19 offset:2048
    ds_read_b64_tr_b16 v[194:195], v19 offset:2560
    v_lshlrev_b32 v219, 16, v132
    v_and_b32 v220, s58, v132
    v_fmac_f32 v217, v219, v219
    v_fmac_f32 v218, v220, v220
    v_lshlrev_b32 v219, 16, v133
    v_and_b32 v220, s58, v133
    v_fmac_f32 v217, v219, v219
    v_fmac_f32 v218, v220, v220
    v_mfma_f32_32x32x16_bf16 v[56:71], v[212:215], v[132:135], v[56:71]
    ds_read_b64_tr_b16 v[196:197], v20 offset:2048
    ds_read_b64_tr_b16 v[198:199], v20 offset:2560
    v_lshlrev_b32 v219, 16, v134
    v_and_b32 v220, s58, v134
    v_fmac_f32 v217, v219, v219
    v_fmac_f32 v218, v220, v220
    v_lshlrev_b32 v219, 16, v135
    v_and_b32 v220, s58, v135
    v_fmac_f32 v217, v219, v219
    v_fmac_f32 v218, v220, v220
    s_waitcnt lgkmcnt(5)
    v_mfma_f32_32x32x16_bf16 v[40:55], v[184:187], v[136:139], v[40:55]
    ds_read_b128 v[144:147], v26 offset:0
    ds_read_b64_tr_b16 v[200:201], v19 offset:4096
    ds_read_b64_tr_b16 v[202:203], v19 offset:4608
    v_lshlrev_b32 v219, 16, v136
    v_and_b32 v220, s58, v136
    v_fmac_f32 v217, v219, v219
    v_fmac_f32 v218, v220, v220
    v_lshlrev_b32 v219, 16, v137
    v_and_b32 v220, s58, v137
    v_fmac_f32 v217, v219, v219
    v_fmac_f32 v218, v220, v220
    v_mfma_f32_32x32x16_bf16 v[56:71], v[188:191], v[136:139], v[56:71]
    ds_read_b64_tr_b16 v[204:205], v20 offset:4096
    ds_read_b64_tr_b16 v[206:207], v20 offset:4608
    v_lshlrev_b32 v219, 16, v138
    v_and_b32 v220, s58, v138
    v_fmac_f32 v217, v219, v219
    v_fmac_f32 v218, v220, v220
    v_lshlrev_b32 v219, 16, v139
    v_and_b32 v220, s58, v139
    v_fmac_f32 v217, v219, v219
    v_fmac_f32 v218, v220, v220
    s_waitcnt lgkmcnt(5)
    v_mfma_f32_32x32x16_bf16 v[40:55], v[192:195], v[140:143], v[40:55]
    ds_read_b128 v[148:151], v27 offset:0
    ds_read_b64_tr_b16 v[208:209], v19 offset:6144
    ds_read_b64_tr_b16 v[210:211], v19 offset:6656
    v_lshlrev_b32 v219, 16, v140
    v_and_b32 v220, s58, v140
    v_fmac_f32 v217, v219, v219
    v_fmac_f32 v218, v220, v220
    v_lshlrev_b32 v219, 16, v141
    v_and_b32 v220, s58, v141
    v_fmac_f32 v217, v219, v219
    v_fmac_f32 v218, v220, v220
    v_mfma_f32_32x32x16_bf16 v[56:71], v[196:199], v[140:143], v[56:71]
    ds_read_b64_tr_b16 v[212:213], v20 offset:6144
    ds_read_b64_tr_b16 v[214:215], v20 offset:6656
    v_lshlrev_b32 v219, 16, v142
    v_and_b32 v220, s58, v142
    v_fmac_f32 v217, v219, v219
    v_fmac_f32 v218, v220, v220
    v_lshlrev_b32 v219, 16, v143
    v_and_b32 v220, s58, v143
    v_fmac_f32 v217, v219, v219
    v_fmac_f32 v218, v220, v220
    s_barrier
    s_waitcnt lgkmcnt(5)
    v_mfma_f32_32x32x16_bf16 v[40:55], v[200:203], v[144:147], v[40:55]
    ds_read_b128 v[152:155], v24 offset:24576
    ds_read_b64_tr_b16 v[184:185], v19 offset:24576
    ds_read_b64_tr_b16 v[186:187], v19 offset:25088
    v_lshlrev_b32 v219, 16, v144
    v_and_b32 v220, s58, v144
    v_fmac_f32 v217, v219, v219
    v_fmac_f32 v218, v220, v220
    v_lshlrev_b32 v219, 16, v145
    v_and_b32 v220, s58, v145
    v_fmac_f32 v217, v219, v219
    v_fmac_f32 v218, v220, v220
    v_mfma_f32_32x32x16_bf16 v[56:71], v[204:207], v[144:147], v[56:71]
    ds_read_b64_tr_b16 v[188:189], v20 offset:24576
    ds_read_b64_tr_b16 v[190:191], v20 offset:25088
    v_lshlrev_b32 v219, 16, v146
    v_and_b32 v220, s58, v146
    v_fmac_f32 v217, v219, v219
    v_fmac_f32 v218, v220, v220
    v_lshlrev_b32 v219, 16, v147
    v_and_b32 v220, s58, v147
    v_fmac_f32 v217, v219, v219
    v_fmac_f32 v218, v220, v220
    s_waitcnt lgkmcnt(5)
    v_mfma_f32_32x32x16_bf16 v[40:55], v[208:211], v[148:151], v[40:55]
    ds_read_b128 v[156:159], v25 offset:24576
    ds_read_b64_tr_b16 v[192:193], v19 offset:26624
    ds_read_b64_tr_b16 v[194:195], v19 offset:27136
    v_lshlrev_b32 v219, 16, v148
    v_and_b32 v220, s58, v148
    v_fmac_f32 v217, v219, v219
    v_fmac_f32 v218, v220, v220
    v_lshlrev_b32 v219, 16, v149
    v_and_b32 v220, s58, v149
    v_fmac_f32 v217, v219, v219
    v_fmac_f32 v218, v220, v220
    v_mfma_f32_32x32x16_bf16 v[56:71], v[212:215], v[148:151], v[56:71]
    ds_read_b64_tr_b16 v[196:197], v20 offset:26624
    ds_read_b64_tr_b16 v[198:199], v20 offset:27136
    v_lshlrev_b32 v219, 16, v150
    v_and_b32 v220, s58, v150
    v_fmac_f32 v217, v219, v219
    v_fmac_f32 v218, v220, v220
    v_lshlrev_b32 v219, 16, v151
    v_and_b32 v220, s58, v151
    v_fmac_f32 v217, v219, v219
    v_fmac_f32 v218, v220, v220
    s_waitcnt lgkmcnt(5)
    v_mfma_f32_32x32x16_bf16 v[40:55], v[184:187], v[152:155], v[40:55]
    ds_read_b128 v[160:163], v26 offset:24576
    ds_read_b64_tr_b16 v[200:201], v19 offset:28672
    ds_read_b64_tr_b16 v[202:203], v19 offset:29184
    v_lshlrev_b32 v219, 16, v152
    v_and_b32 v220, s58, v152
    v_fmac_f32 v217, v219, v219
    v_fmac_f32 v218, v220, v220
    v_lshlrev_b32 v219, 16, v153
    v_and_b32 v220, s58, v153
    v_fmac_f32 v217, v219, v219
    v_fmac_f32 v218, v220, v220
    v_mfma_f32_32x32x16_bf16 v[56:71], v[188:191], v[152:155], v[56:71]
    ds_read_b64_tr_b16 v[204:205], v20 offset:28672
    ds_read_b64_tr_b16 v[206:207], v20 offset:29184
    v_lshlrev_b32 v219, 16, v154
    v_and_b32 v220, s58, v154
    v_fmac_f32 v217, v219, v219
    v_fmac_f32 v218, v220, v220
    v_lshlrev_b32 v219, 16, v155
    v_and_b32 v220, s58, v155
    v_fmac_f32 v217, v219, v219
    v_fmac_f32 v218, v220, v220
    s_waitcnt lgkmcnt(5)
    v_mfma_f32_32x32x16_bf16 v[40:55], v[192:195], v[156:159], v[40:55]
    ds_read_b128 v[164:167], v27 offset:24576
    ds_read_b64_tr_b16 v[208:209], v19 offset:30720
    ds_read_b64_tr_b16 v[210:211], v19 offset:31232
    v_lshlrev_b32 v219, 16, v156
    v_and_b32 v220, s58, v156
    v_fmac_f32 v217, v219, v219
    v_fmac_f32 v218, v220, v220
    v_lshlrev_b32 v219, 16, v157
    v_and_b32 v220, s58, v157
    v_fmac_f32 v217, v219, v219
    v_fmac_f32 v218, v220, v220
    v_mfma_f32_32x32x16_bf16 v[56:71], v[196:199], v[156:159], v[56:71]
    ds_read_b64_tr_b16 v[212:213], v20 offset:30720
    ds_read_b64_tr_b16 v[214:215], v20 offset:31232
    v_lshlrev_b32 v219, 16, v158
    v_and_b32 v220, s58, v158
    v_fmac_f32 v217, v219, v219
    v_fmac_f32 v218, v220, v220
    v_lshlrev_b32 v219, 16, v159
    v_and_b32 v220, s58, v159
    v_fmac_f32 v217, v219, v219
    v_fmac_f32 v218, v220, v220
    s_barrier
    s_waitcnt lgkmcnt(5)
    v_mfma_f32_32x32x16_bf16 v[40:55], v[200:203], v[160:163], v[40:55]
    ds_read_b128 v[168:171], v28 offset:0
    ds_read_b64_tr_b16 v[184:185], v32 offset:0
    ds_read_b64_tr_b16 v[186:187], v32 offset:512
    v_lshlrev_b32 v219, 16, v160
    v_and_b32 v220, s58, v160
    v_fmac_f32 v217, v219, v219
    v_fmac_f32 v218, v220, v220
    v_lshlrev_b32 v219, 16, v161
    v_and_b32 v220, s58, v161
    v_fmac_f32 v217, v219, v219
    v_fmac_f32 v218, v220, v220
    v_mfma_f32_32x32x16_bf16 v[56:71], v[204:207], v[160:163], v[56:71]
    ds_read_b64_tr_b16 v[188:189], v33 offset:0
    ds_read_b64_tr_b16 v[190:191], v33 offset:512
    v_lshlrev_b32 v219, 16, v162
    v_and_b32 v220, s58, v162
    v_fmac_f32 v217, v219, v219
    v_fmac_f32 v218, v220, v220
    v_lshlrev_b32 v219, 16, v163
    v_and_b32 v220, s58, v163
    v_fmac_f32 v217, v219, v219
    v_fmac_f32 v218, v220, v220
    s_waitcnt lgkmcnt(5)
    v_mfma_f32_32x32x16_bf16 v[40:55], v[208:211], v[164:167], v[40:55]
    ds_read_b128 v[172:175], v29 offset:0
    ds_read_b64_tr_b16 v[192:193], v32 offset:2048
    ds_read_b64_tr_b16 v[194:195], v32 offset:2560
    v_lshlrev_b32 v219, 16, v164
    v_and_b32 v220, s58, v164
    v_fmac_f32 v217, v219, v219
    v_fmac_f32 v218, v220, v220
    v_lshlrev_b32 v219, 16, v165
    v_and_b32 v220, s58, v165
    v_fmac_f32 v217, v219, v219
    v_fmac_f32 v218, v220, v220
    v_mfma_f32_32x32x16_bf16 v[56:71], v[212:215], v[164:167], v[56:71]
    ds_read_b64_tr_b16 v[196:197], v33 offset:2048
    ds_read_b64_tr_b16 v[198:199], v33 offset:2560
    v_lshlrev_b32 v219, 16, v166
    v_and_b32 v220, s58, v166
    v_fmac_f32 v217, v219, v219
    v_fmac_f32 v218, v220, v220
    v_lshlrev_b32 v219, 16, v167
    v_and_b32 v220, s58, v167
    v_fmac_f32 v217, v219, v219
    v_fmac_f32 v218, v220, v220
    s_waitcnt lgkmcnt(5)
    v_mfma_f32_32x32x16_bf16 v[40:55], v[184:187], v[168:171], v[40:55]
    ds_read_b128 v[176:179], v30 offset:0
    ds_read_b64_tr_b16 v[200:201], v32 offset:4096
    ds_read_b64_tr_b16 v[202:203], v32 offset:4608
    v_lshlrev_b32 v219, 16, v168
    v_and_b32 v220, s58, v168
    v_fmac_f32 v217, v219, v219
    v_fmac_f32 v218, v220, v220
    v_lshlrev_b32 v219, 16, v169
    v_and_b32 v220, s58, v169
    v_fmac_f32 v217, v219, v219
    v_fmac_f32 v218, v220, v220
    v_mfma_f32_32x32x16_bf16 v[56:71], v[188:191], v[168:171], v[56:71]
    ds_read_b64_tr_b16 v[204:205], v33 offset:4096
    ds_read_b64_tr_b16 v[206:207], v33 offset:4608
    v_lshlrev_b32 v219, 16, v170
    v_and_b32 v220, s58, v170
    v_fmac_f32 v217, v219, v219
    v_fmac_f32 v218, v220, v220
    v_lshlrev_b32 v219, 16, v171
    v_and_b32 v220, s58, v171
    v_fmac_f32 v217, v219, v219
    v_fmac_f32 v218, v220, v220
    s_waitcnt lgkmcnt(5)
    v_mfma_f32_32x32x16_bf16 v[40:55], v[192:195], v[172:175], v[40:55]
    ds_read_b128 v[180:183], v31 offset:0
    ds_read_b64_tr_b16 v[208:209], v32 offset:6144
    ds_read_b64_tr_b16 v[210:211], v32 offset:6656
    v_lshlrev_b32 v219, 16, v172
    v_and_b32 v220, s58, v172
    v_fmac_f32 v217, v219, v219
    v_fmac_f32 v218, v220, v220
    v_lshlrev_b32 v219, 16, v173
    v_and_b32 v220, s58, v173
    v_fmac_f32 v217, v219, v219
    v_fmac_f32 v218, v220, v220
    v_mfma_f32_32x32x16_bf16 v[56:71], v[196:199], v[172:175], v[56:71]
    ds_read_b64_tr_b16 v[212:213], v33 offset:6144
    ds_read_b64_tr_b16 v[214:215], v33 offset:6656
    v_lshlrev_b32 v219, 16, v174
    v_and_b32 v220, s58, v174
    v_fmac_f32 v217, v219, v219
    v_fmac_f32 v218, v220, v220
    v_lshlrev_b32 v219, 16, v175
    v_and_b32 v220, s58, v175
    v_fmac_f32 v217, v219, v219
    v_fmac_f32 v218, v220, v220
    s_barrier
    s_waitcnt lgkmcnt(5)
    v_mfma_f32_32x32x16_bf16 v[40:55], v[200:203], v[176:179], v[40:55]
    v_lshlrev_b32 v219, 16, v176
    v_and_b32 v220, s58, v176
    v_fmac_f32 v217, v219, v219
    v_fmac_f32 v218, v220, v220
    v_lshlrev_b32 v219, 16, v177
    v_and_b32 v220, s58, v177
    v_fmac_f32 v217, v219, v219
    v_fmac_f32 v218, v220, v220
    v_mfma_f32_32x32x16_bf16 v[56:71], v[204:207], v[176:179], v[56:71]
    v_lshlrev_b32 v219, 16, v178
    v_and_b32 v220, s58, v178
    v_fmac_f32 v217, v219, v219
    v_fmac_f32 v218, v220, v220
    v_lshlrev_b32 v219, 16, v179
    v_and_b32 v220, s58, v179
    v_fmac_f32 v217, v219, v219
    v_fmac_f32 v218, v220, v220
    s_waitcnt lgkmcnt(0)
    v_mfma_f32_32x32x16_bf16 v[40:55], v[208:211], v[180:183], v[40:55]
    v_lshlrev_b32 v219, 16, v180
    v_and_b32 v220, s58, v180
    v_fmac_f32 v217, v219, v219
    v_fmac_f32 v218, v220, v220
    v_lshlrev_b32 v219, 16, v181
    v_and_b32 v220, s58, v181
    v_fmac_f32 v217, v219, v219
    v_fmac_f32 v218, v220, v220
    v_mfma_f32_32x32x16_bf16 v[56:71], v[212:215], v[180:183], v[56:71]
    v_lshlrev_b32 v219, 16, v182
    v_and_b32 v220, s58, v182
    v_fmac_f32 v217, v219, v219
    v_fmac_f32 v218, v220, v220
    v_lshlrev_b32 v219, 16, v183
    v_and_b32 v220, s58, v183
    v_fmac_f32 v217, v219, v219
    v_fmac_f32 v218, v220, v220
    ds_read_b128 v[184:187], v223 offset:0
    ds_read_b128 v[188:191], v223 offset:1024
    v_add_f32 v217, v217, v218
    v_mov_b32 v226, v217
    s_nop 1
    v_permlane32_swap_b32 v217, v226
    v_add_f32 v217, v217, v226
    v_mov_b32 v240, 0
    v_mov_b32 v241, 0
    v_mov_b32 v226, v68
    v_mov_b32 v216, v68
    s_nop 1
    v_permlane32_swap_b32 v226, v216
    v_mul_f32 v216, 0xbb124925, v216
    v_mul_f32 v217, 0x3b124925, v217
    v_fma_f32 v226, -v216, v216, v217
    v_max_f32 v226, 0, v226
    v_add_f32 v226, 0x3727c5ac, v226
    v_rsq_f32 v232, v226
    v_cvt_pk_bf16_f32 v228, v216, v216
    v_lshlrev_b32 v227, 16, v228
    v_sub_f32 v227, v216, v227
    v_mov_b32 v230, 0
    v_cvt_pk_bf16_f32 v229, v227, v230
    v_mov_b32 v231, 0
    s_waitcnt lgkmcnt(0)
    v_add_f32 v188, v188, v189
    v_add_f32 v190, v190, v191
    v_add_f32 v188, v188, v190
    v_mul_f32 v188, 0.5, v188
    v_cvt_pk_bf16_f32 v239, v188, v188
    v_lshlrev_b32 v226, 16, v239
    v_sub_f32 v188, v188, v226
    v_cvt_pk_bf16_f32 v238, v226, v188
    v_add_f32 v184, v184, v185
    v_mov_b32 v185, 0
    v_mfma_f32_32x32x16_bf16 v[56:71], v[238:241], v[228:231], v[56:71]
    v_add_f32 v184, v184, v185
    v_add_f32 v186, v186, v187
    v_add_f32 v184, v184, v186
    v_mul_f32 v184, 0.5, v184
    v_cvt_pk_bf16_f32 v237, v184, v184
    v_lshlrev_b32 v226, 16, v237
    v_sub_f32 v184, v184, v226
    v_cvt_pk_bf16_f32 v236, v226, v184
    s_nop 1
    v_mfma_f32_32x32x16_bf16 v[40:55], v[236:239], v[228:231], v[40:55]
    s_nop 0
    v_mul_f32 v56, v56, v232
    v_mul_f32 v57, v57, v232
    v_mul_f32 v58, v58, v232
    v_mul_f32 v59, v59, v232
    v_mul_f32 v60, v60, v232
    v_mul_f32 v61, v61, v232
    v_mul_f32 v62, v62, v232
    v_mul_f32 v63, v63, v232
    v_mul_f32 v64, v64, v232
    v_mul_f32 v65, v65, v232
    v_mul_f32 v66, v66, v232
    v_mul_f32 v67, v67, v232
    v_mul_f32 v68, v68, v232
    v_mul_f32 v69, v69, v232
    v_mul_f32 v70, v70, v232
    v_mul_f32 v71, v71, v232
    v_cvt_pk_bf16_f32 v200, v56, v57
    v_cvt_pk_bf16_f32 v201, v58, v59
    v_cvt_pk_bf16_f32 v202, v60, v61
    v_cvt_pk_bf16_f32 v203, v62, v63
    v_cvt_pk_bf16_f32 v204, v64, v65
    v_cvt_pk_bf16_f32 v205, v66, v67
    v_cvt_pk_bf16_f32 v206, v68, v69
    v_cvt_pk_bf16_f32 v207, v70, v71
    v_cndmask_b32 v206, v206, v36, s[30:31]
    v_cndmask_b32 v207, v207, v38, s[30:31]
    buffer_store_dwordx4 v[200:203], v221, s[24:27], s45 offen sc1
    buffer_store_dwordx4 v[204:207], v222, s[24:27], s45 offen sc1
    v_mul_f32 v40, v40, v232
    v_mul_f32 v41, v41, v232
    v_mul_f32 v42, v42, v232
    v_mul_f32 v43, v43, v232
    v_mul_f32 v44, v44, v232
    v_mul_f32 v45, v45, v232
    v_mul_f32 v46, v46, v232
    v_mul_f32 v47, v47, v232
    v_mul_f32 v48, v48, v232
    v_mul_f32 v49, v49, v232
    v_mul_f32 v50, v50, v232
    v_mul_f32 v51, v51, v232
    v_mul_f32 v52, v52, v232
    v_mul_f32 v53, v53, v232
    v_mul_f32 v54, v54, v232
    v_mul_f32 v55, v55, v232
    v_cvt_pk_bf16_f32 v192, v40, v41
    v_cvt_pk_bf16_f32 v193, v42, v43
    v_cvt_pk_bf16_f32 v194, v44, v45
    v_cvt_pk_bf16_f32 v195, v46, v47
    v_cvt_pk_bf16_f32 v196, v48, v49
    v_cvt_pk_bf16_f32 v197, v50, v51
    v_cvt_pk_bf16_f32 v198, v52, v53
    v_cvt_pk_bf16_f32 v199, v54, v55
    v_cndmask_b32 v198, v198, v36, s[30:31]
    v_cndmask_b32 v199, v199, v38, s[30:31]
    buffer_store_dwordx4 v[192:195], v221, s[24:27], s59 offen sc1
    buffer_store_dwordx4 v[196:199], v222, s[24:27], s59 offen sc1
    s_and_b32 s37, s43, 7
    s_lshl_b32 s37, s37, 6
    s_lshl_b32 s36, s42, 1
    s_add_u32 s37, s37, s36
    s_lshr_b32 s36, s43, 3
    s_add_u32 s37, s37, s36
    s_lshl_b32 s37, s37, 3
    s_add_u32 s37, s37, 23527424
    v_lshrrev_b32 v8, 1, v1
    v_lshlrev_b32 v8, 12, v8
    v_and_b32 v9, 1, v1
    v_lshl_add_u32 v8, v9, 8, v8
    s_mov_b32 s34, 0
GE_sequential_preLN__softmax_full_mha__glu_gated_reglu__prompt_kernel_18:
    s_waitcnt vmcnt(0)
    v_cmp_eq_u32 vcc, 0, v4
    s_add_u32 s34, s34, 1
    s_cmp_gt_u32 s34, 65536
    s_cbranch_vccz GE_sequential_preLN__softmax_full_mha__glu_gated_reglu__prompt_kernel_19
    s_cbranch_scc1 GE_sequential_preLN__softmax_full_mha__glu_gated_reglu__prompt_kernel_19
    v_mov_b32 v6, 0
    global_load_dwordx2 v[4:5], v6, s[20:21] sc1
    s_branch GE_sequential_preLN__softmax_full_mha__glu_gated_reglu__prompt_kernel_18
GE_sequential_preLN__softmax_full_mha__glu_gated_reglu__prompt_kernel_19:
    v_mov_b32 v6, 163776
    v_mov_b32 v7, 1
    s_mov_b64 exec, 1
    ds_add_rtn_u32 v7, v6, v7
    s_waitcnt lgkmcnt(0)
    v_readfirstlane_b32 s34, v7
    s_mov_b64 exec, -1
    s_cmp_lg_u32 s34, 3
    s_cbranch_scc1 AR_sequential_preLN__softmax_full_mha__glu_gated_reglu__prompt_kernel_20
    s_mov_b64 exec, 0xffffffff
    buffer_store_dwordx2 v[4:5], v8, s[24:27], s37 offen sc1
    s_mov_b64 exec, -1
AR_sequential_preLN__softmax_full_mha__glu_gated_reglu__prompt_kernel_20:
    s_barrier
    ds_read_b64_tr_b16 v[40:41], v21 offset:0
    ds_read_b64_tr_b16 v[42:43], v21 offset:256
    ds_read_b64_tr_b16 v[44:45], v21 offset:1024
    ds_read_b64_tr_b16 v[46:47], v21 offset:1280
    ds_read_b64_tr_b16 v[48:49], v21 offset:2048
    ds_read_b64_tr_b16 v[50:51], v21 offset:2304
    ds_read_b64_tr_b16 v[52:53], v21 offset:3072
    ds_read_b64_tr_b16 v[54:55], v21 offset:3328
    ds_read_b64_tr_b16 v[208:209], v21 offset:4096
    ds_read_b64_tr_b16 v[210:211], v21 offset:4352
    ds_read_b64_tr_b16 v[212:213], v21 offset:5120
    ds_read_b64_tr_b16 v[214:215], v21 offset:5376
    s_waitcnt lgkmcnt(10)
    v_mfma_f32_32x32x16_bf16 v[56:71], v[40:43], v[72:75], 0
    ds_read_b64_tr_b16 v[184:185], v21 offset:6144
    ds_read_b64_tr_b16 v[186:187], v21 offset:6400
    s_waitcnt lgkmcnt(10)
    v_mfma_f32_32x32x16_bf16 v[56:71], v[44:47], v[76:79], v[56:71]
    ds_read_b64_tr_b16 v[188:189], v21 offset:7168
    ds_read_b64_tr_b16 v[190:191], v21 offset:7424
    s_waitcnt lgkmcnt(10)
    v_mfma_f32_32x32x16_bf16 v[56:71], v[48:51], v[80:83], v[56:71]
    ds_read_b64_tr_b16 v[40:41], v21 offset:8192
    ds_read_b64_tr_b16 v[42:43], v21 offset:8448
    s_waitcnt lgkmcnt(10)
    v_mfma_f32_32x32x16_bf16 v[56:71], v[52:55], v[84:87], v[56:71]
    ds_read_b64_tr_b16 v[44:45], v21 offset:9216
    ds_read_b64_tr_b16 v[46:47], v21 offset:9472
    s_waitcnt lgkmcnt(10)
    v_mfma_f32_32x32x16_bf16 v[56:71], v[208:211], v[88:91], v[56:71]
    ds_read_b64_tr_b16 v[48:49], v21 offset:10240
    ds_read_b64_tr_b16 v[50:51], v21 offset:10496
    s_waitcnt lgkmcnt(10)
    v_mfma_f32_32x32x16_bf16 v[56:71], v[212:215], v[92:95], v[56:71]
    ds_read_b64_tr_b16 v[52:53], v21 offset:11264
    ds_read_b64_tr_b16 v[54:55], v21 offset:11520
    s_waitcnt lgkmcnt(10)
    v_mfma_f32_32x32x16_bf16 v[56:71], v[184:187], v[96:99], v[56:71]
    ds_read_b64_tr_b16 v[208:209], v21 offset:12288
    ds_read_b64_tr_b16 v[210:211], v21 offset:12544
    s_waitcnt lgkmcnt(10)
    v_mfma_f32_32x32x16_bf16 v[56:71], v[188:191], v[100:103], v[56:71]
    ds_read_b64_tr_b16 v[212:213], v21 offset:13312
    ds_read_b64_tr_b16 v[214:215], v21 offset:13568
    s_waitcnt lgkmcnt(10)
    v_mfma_f32_32x32x16_bf16 v[56:71], v[40:43], v[104:107], v[56:71]
    ds_read_b64_tr_b16 v[184:185], v21 offset:14336
    ds_read_b64_tr_b16 v[186:187], v21 offset:14592
    s_waitcnt lgkmcnt(10)
    v_mfma_f32_32x32x16_bf16 v[56:71], v[44:47], v[108:111], v[56:71]
    ds_read_b64_tr_b16 v[188:189], v21 offset:15360
    ds_read_b64_tr_b16 v[190:191], v21 offset:15616
    s_waitcnt lgkmcnt(10)
    v_mfma_f32_32x32x16_bf16 v[56:71], v[48:51], v[112:115], v[56:71]
    ds_read_b64_tr_b16 v[40:41], v21 offset:16384
    ds_read_b64_tr_b16 v[42:43], v21 offset:16640
    s_waitcnt lgkmcnt(10)
    v_mfma_f32_32x32x16_bf16 v[56:71], v[52:55], v[116:119], v[56:71]
    ds_read_b64_tr_b16 v[44:45], v21 offset:17408
    ds_read_b64_tr_b16 v[46:47], v21 offset:17664
    s_waitcnt lgkmcnt(10)
    v_mfma_f32_32x32x16_bf16 v[56:71], v[208:211], v[120:123], v[56:71]
    ds_read_b64_tr_b16 v[48:49], v21 offset:18432
    ds_read_b64_tr_b16 v[50:51], v21 offset:18688
    s_waitcnt lgkmcnt(10)
    v_mfma_f32_32x32x16_bf16 v[56:71], v[212:215], v[124:127], v[56:71]
    ds_read_b64_tr_b16 v[52:53], v21 offset:19456
    ds_read_b64_tr_b16 v[54:55], v21 offset:19712
    s_waitcnt lgkmcnt(10)
    v_mfma_f32_32x32x16_bf16 v[56:71], v[184:187], v[128:131], v[56:71]
    ds_read_b64_tr_b16 v[208:209], v21 offset:20480
    ds_read_b64_tr_b16 v[210:211], v21 offset:20736
    s_barrier
    s_waitcnt lgkmcnt(10)
    v_mfma_f32_32x32x16_bf16 v[56:71], v[188:191], v[132:135], v[56:71]
    ds_read_b64_tr_b16 v[212:213], v21 offset:21504
    ds_read_b64_tr_b16 v[214:215], v21 offset:21760
    s_waitcnt lgkmcnt(10)
    v_mfma_f32_32x32x16_bf16 v[56:71], v[40:43], v[136:139], v[56:71]
    ds_read_b64_tr_b16 v[184:185], v21 offset:22528
    ds_read_b64_tr_b16 v[186:187], v21 offset:22784
    s_waitcnt lgkmcnt(10)
    v_mfma_f32_32x32x16_bf16 v[56:71], v[44:47], v[140:143], v[56:71]
    ds_read_b64_tr_b16 v[188:189], v21 offset:23552
    ds_read_b64_tr_b16 v[190:191], v21 offset:23808
    s_waitcnt lgkmcnt(10)
    v_mfma_f32_32x32x16_bf16 v[56:71], v[48:51], v[144:147], v[56:71]
    ds_read_b64_tr_b16 v[40:41], v21 offset:24576
    ds_read_b64_tr_b16 v[42:43], v21 offset:24832
    s_waitcnt lgkmcnt(10)
    v_mfma_f32_32x32x16_bf16 v[56:71], v[52:55], v[148:151], v[56:71]
    ds_read_b64_tr_b16 v[44:45], v21 offset:25600
    ds_read_b64_tr_b16 v[46:47], v21 offset:25856
    s_waitcnt lgkmcnt(10)
    v_mfma_f32_32x32x16_bf16 v[56:71], v[208:211], v[152:155], v[56:71]
    ds_read_b64_tr_b16 v[48:49], v21 offset:26624
    ds_read_b64_tr_b16 v[50:51], v21 offset:26880
    s_waitcnt lgkmcnt(10)
    v_mfma_f32_32x32x16_bf16 v[56:71], v[212:215], v[156:159], v[56:71]
    ds_read_b64_tr_b16 v[52:53], v21 offset:27648
    ds_read_b64_tr_b16 v[54:55], v21 offset:27904
    s_waitcnt lgkmcnt(10)
    v_mfma_f32_32x32x16_bf16 v[56:71], v[184:187], v[160:163], v[56:71]
    s_waitcnt lgkmcnt(8)
    v_mfma_f32_32x32x16_bf16 v[56:71], v[188:191], v[164:167], v[56:71]
    s_waitcnt lgkmcnt(6)
    v_mfma_f32_32x32x16_bf16 v[56:71], v[40:43], v[168:171], v[56:71]
    s_waitcnt lgkmcnt(4)
    v_mfma_f32_32x32x16_bf16 v[56:71], v[44:47], v[172:175], v[56:71]
    s_waitcnt lgkmcnt(2)
    v_mfma_f32_32x32x16_bf16 v[56:71], v[48:51], v[176:179], v[56:71]
    s_waitcnt lgkmcnt(0)
    v_mfma_f32_32x32x16_bf16 v[56:71], v[52:55], v[180:183], v[56:71]
    ds_read_b128 v[184:187], v223 offset:2048
    v_mul_f32 v232, 0x3e8b97f6, v232
    s_waitcnt lgkmcnt(0)
    v_add_f32 v184, v184, v185
    v_add_f32 v186, v186, v187
    v_add_f32 v184, v184, v186
    v_mul_f32 v184, 0.5, v184
    v_cvt_pk_bf16_f32 v239, v184, v184
    v_lshlrev_b32 v226, 16, v239
    v_sub_f32 v184, v184, v226
    v_cvt_pk_bf16_f32 v238, v226, v184
    s_nop 1
    v_mfma_f32_32x32x16_bf16 v[56:71], v[238:241], v[228:231], v[56:71]
    s_nop 11
    v_mul_f32 v56, v56, v232
    v_mul_f32 v57, v57, v232
    v_mul_f32 v58, v58, v232
    v_mul_f32 v59, v59, v232
    v_mul_f32 v60, v60, v232
    v_mul_f32 v61, v61, v232
    v_mul_f32 v62, v62, v232
    v_mul_f32 v63, v63, v232
    v_mul_f32 v64, v64, v232
    v_mul_f32 v65, v65, v232
    v_mul_f32 v66, v66, v232
    v_mul_f32 v67, v67, v232
    v_mul_f32 v68, v68, v232
    v_mul_f32 v69, v69, v232
    v_mul_f32 v70, v70, v232
    v_mul_f32 v71, v71, v232
    v_cvt_pk_bf16_f32 v192, v56, v57
    v_cvt_pk_bf16_f32 v193, v58, v59
    v_cvt_pk_bf16_f32 v194, v60, v61
    v_cvt_pk_bf16_f32 v195, v62, v63
    v_cvt_pk_bf16_f32 v196, v64, v65
    v_cvt_pk_bf16_f32 v197, v66, v67
    v_cvt_pk_bf16_f32 v198, v68, v69
    v_cvt_pk_bf16_f32 v199, v70, v71
    v_cndmask_b32 v198, v198, v231, s[30:31]
    v_cndmask_b32 v199, v199, v231, s[30:31]
    ds_write_b128 v224, v[192:195]
    ds_write_b128 v224, v[196:199] offset:1024
    s_waitcnt lgkmcnt(0)
    v_mov_b32 v236, 0x40000000
    v_mov_b32 v237, 0x40000000
    v_mov_b32 v238, 0x40000000
    v_mov_b32 v244, 0x40000000
    v_mov_b32 v245, 0x40000000
    s_mov_b32 s76, s22
    s_mov_b32 s77, s23
    s_mov_b32 s78, 0
    s_mov_b32 s79, 0x20000
    s_mov_b32 s80, s22
    s_mov_b32 s81, s23
    s_mov_b32 s82, 0
    s_mov_b32 s83, 0x20000
P1J_sequential_preLN__softmax_full_mha__glu_gated_reglu__prompt_kernel_3:
    s_bfe_u32 s46, s2, 0x20000
    s_lshl_b32 s46, s46, 2
    s_bfe_u32 s47, s2, 0x20003
    s_add_u32 s43, s46, s47
    s_bfe_u32 s46, s2, 0x10002
    s_lshl_b32 s46, s46, 3
    s_lshr_b32 s47, s2, 5
    s_add_u32 s42, s46, s47
    s_and_b32 s44, s28, 1
    s_lshr_b32 s45, s28, 1
    s_add_u32 s46, s42, 16
    s_lshl_b32 s46, s46, 17
    s_lshl_b32 s47, s45, 4
    s_add_u32 s47, s47, s44
    s_lshl_b32 s47, s47, 11
    s_add_u32 s57, s46, s47
    s_lshl_b32 s54, s28, 12
    s_lshl_b32 s58, s43, 2
    s_lshl_b32 s48, s44, 1
    s_add_u32 s58, s58, s48
    s_lshr_b32 s48, s45, 1
    s_add_u32 s58, s58, s48
    s_bitcmp1_b32 s45, 0
    s_cselect_b64 s[62:63], -1, 0
    s_lshl_b32 s59, s58, 5
    s_lshl_b32 s46, s42, 1
    s_add_u32 s59, s59, s46
    s_and_b32 s47, s45, 1
    s_add_u32 s59, s59, s47
    s_lshl_b32 s59, s59, 10
    s_add_u32 s59, s59, 6291456
    s_cmp_eq_u32 s45, 0
    s_cselect_b32 s60, 0xd800000, -1.0
    s_lshl_b32 s46, s45, 13
    v_add_u32 v32, s46, v2
    v_add_u32 v33, 65536, v32
    v_bfe_u32 v37, v1, 4, 1
    v_xor_b32 v37, s47, v37
    v_lshrrev_b32 v36, 5, v1
    v_xor_b32 v36, v36, v37
    v_lshlrev_b32 v36, 7, v36
    v_lshl_add_u32 v36, v37, 10, v36
    v_bfe_u32 v37, v1, 2, 2
    v_lshl_add_u32 v36, v37, 5, v36
    v_and_b32 v37, 1, v1
    v_lshl_add_u32 v36, v37, 4, v36
    v_bfe_u32 v37, v1, 1, 1
    v_lshl_add_u32 v36, v37, 3, v36
    v_add_u32 v36, s46, v36
    v_add_u32 v34, 2048, v36
    v_add_u32 v35, 67584, v36
    s_xor_b32 s46, s28, 0
    s_cmp_lt_u32 s46, 4
    s_mov_b32 s47, 102528
    s_cselect_b32 s47, 65536, s47
    s_mul_i32 s46, s46, 7168
    s_add_u32 s46, s46, s47
    v_add_u32 v37, s46, v2
    s_xor_b32 s46, s28, 2
    s_cmp_lt_u32 s46, 4
    s_mov_b32 s47, 102528
    s_cselect_b32 s47, 65536, s47
    s_mul_i32 s46, s46, 7168
    s_add_u32 s46, s46, s47
    v_add_u32 v38, s46, v2
    s_xor_b32 s46, s28, 4
    s_cmp_lt_u32 s46, 4
    s_mov_b32 s47, 104576
    s_cselect_b32 s47, 67584, s47
    s_mul_i32 s46, s46, 7168
    s_add_u32 s46, s46, s47
    v_add_u32 v39, s46, v2
    s_xor_b32 s46, s28, 6
    s_cmp_lt_u32 s46, 4
    s_mov_b32 s47, 106624
    s_cselect_b32 s47, 69632, s47
    s_mul_i32 s46, s46, 7168
    s_add_u32 s46, s46, s47
    v_add_u32 v40, s46, v2
    v_and_b32 v41, 7, v1
    v_lshlrev_b32 v41, 2, v41
    v_add_u32 v41, 131072, v41
    v_mov_b32 v136, 0
    s_mov_b32 s56, 0
    s_and_b32 s46, s58, 3
    s_lshl_b32 s46, s46, 11
    v_add_u32 v132, s46, v2
    v_xor_b32 v133, 2048, v132
    v_add_u32 v132, 98304, v132
    v_add_u32 v133, 98304, v133
    s_cmp_lg_u32 s28, 4
    s_cbranch_scc1 W2_sequential_preLN__softmax_full_mha__glu_gated_reglu__prompt_kernel_21
    s_mov_b32 m0, 32768
    s_add_u32 s36, s37, 2101248
    buffer_load_dwordx4 v2, s[24:27], s36 offen offset:0 sc1 lds
    buffer_load_dwordx4 v2, s[24:27], s36 offen offset:1024 sc1 lds
    s_mov_b32 m0, 36864
    s_add_u32 s36, s37, 2103296
    buffer_load_dwordx4 v2, s[24:27], s36 offen offset:0 sc1 lds
    buffer_load_dwordx4 v2, s[24:27], s36 offen offset:1024 sc1 lds
    s_mov_b32 m0, 40960
    s_add_u32 s36, s37, 2134016
    buffer_load_dwordx4 v2, s[24:27], s36 offen offset:0 sc1 lds
    buffer_load_dwordx4 v2, s[24:27], s36 offen offset:1024 sc1 lds
    s_mov_b32 m0, 45056
    s_add_u32 s36, s37, 2136064
    buffer_load_dwordx4 v2, s[24:27], s36 offen offset:0 sc1 lds
    buffer_load_dwordx4 v2, s[24:27], s36 offen offset:1024 sc1 lds
    s_mov_b32 m0, 49152
    s_add_u32 s36, s37, 2166784
    buffer_load_dwordx4 v2, s[24:27], s36 offen offset:0 sc1 lds
    buffer_load_dwordx4 v2, s[24:27], s36 offen offset:1024 sc1 lds
    s_mov_b32 m0, 53248
    s_add_u32 s36, s37, 2168832
    buffer_load_dwordx4 v2, s[24:27], s36 offen offset:0 sc1 lds
    buffer_load_dwordx4 v2, s[24:27], s36 offen offset:1024 sc1 lds
    s_mov_b32 m0, 57344
    s_add_u32 s36, s37, 2199552
    buffer_load_dwordx4 v2, s[24:27], s36 offen offset:0 sc1 lds
    buffer_load_dwordx4 v2, s[24:27], s36 offen offset:1024 sc1 lds
    s_mov_b32 m0, 61440
    s_add_u32 s36, s37, 2201600
    buffer_load_dwordx4 v2, s[24:27], s36 offen offset:0 sc1 lds
    buffer_load_dwordx4 v2, s[24:27], s36 offen offset:1024 sc1 lds
    s_mov_b32 m0, 32768
    s_add_u32 s36, s37, 4196352
    buffer_load_dwordx4 v2, s[24:27], s36 offen offset:2048 sc1 lds
    buffer_load_dwordx4 v2, s[24:27], s36 offen offset:3072 sc1 lds
    s_mov_b32 m0, 36864
    s_add_u32 s36, s37, 4198400
    buffer_load_dwordx4 v2, s[24:27], s36 offen offset:2048 sc1 lds
    buffer_load_dwordx4 v2, s[24:27], s36 offen offset:3072 sc1 lds
    s_mov_b32 m0, 40960
    s_add_u32 s36, s37, 4229120
    buffer_load_dwordx4 v2, s[24:27], s36 offen offset:2048 sc1 lds
    buffer_load_dwordx4 v2, s[24:27], s36 offen offset:3072 sc1 lds
    s_mov_b32 m0, 45056
    s_add_u32 s36, s37, 4231168
    buffer_load_dwordx4 v2, s[24:27], s36 offen offset:2048 sc1 lds
    buffer_load_dwordx4 v2, s[24:27], s36 offen offset:3072 sc1 lds
    s_mov_b32 m0, 49152
    s_add_u32 s36, s37, 4261888
    buffer_load_dwordx4 v2, s[24:27], s36 offen offset:2048 sc1 lds
    buffer_load_dwordx4 v2, s[24:27], s36 offen offset:3072 sc1 lds
    s_mov_b32 m0, 53248
    s_add_u32 s36, s37, 4263936
    buffer_load_dwordx4 v2, s[24:27], s36 offen offset:2048 sc1 lds
    buffer_load_dwordx4 v2, s[24:27], s36 offen offset:3072 sc1 lds
    s_mov_b32 m0, 57344
    s_add_u32 s36, s37, 4294656
    buffer_load_dwordx4 v2, s[24:27], s36 offen offset:2048 sc1 lds
    buffer_load_dwordx4 v2, s[24:27], s36 offen offset:3072 sc1 lds
    s_mov_b32 m0, 61440
    s_add_u32 s36, s37, 4296704
    buffer_load_dwordx4 v2, s[24:27], s36 offen offset:2048 sc1 lds
    buffer_load_dwordx4 v2, s[24:27], s36 offen offset:3072 sc1 lds
W2_sequential_preLN__softmax_full_mha__glu_gated_reglu__prompt_kernel_21:
    s_waitcnt vmcnt(32)
    s_barrier
    ds_read_b128 v[16:19], v132
    ds_read_b128 v[20:23], v132 offset:1024
    ds_read_b128 v[24:27], v133
    ds_read_b128 v[28:31], v133 offset:1024
    ds_read_b128 v[108:111], v2
    ds_read_b128 v[112:115], v2 offset:1024
    s_waitcnt lgkmcnt(0)
    v_mfma_f32_32x32x16_bf16 v[44:59], v[108:111], v[16:19], 0
    v_mfma_f32_32x32x16_bf16 v[44:59], v[112:115], v[20:23], v[44:59]
    v_mfma_f32_32x32x16_bf16 v[60:75], v[108:111], v[24:27], 0
    v_mfma_f32_32x32x16_bf16 v[60:75], v[112:115], v[28:31], v[60:75]
    ds_read_b128 v[108:111], v32 offset:0
    ds_read_b128 v[112:115], v32 offset:1024
    s_nop 7
    v_max3_f32 v132, v44, v45, v46
    v_max3_f32 v132, v132, v47, v48
    v_cvt_pk_bf16_f32 v132, -v132, v136
    v_cndmask_b32 v22, v22, v132, s[30:31]
    v_max3_f32 v133, v60, v61, v62
    v_max3_f32 v133, v133, v63, v64
    v_cvt_pk_bf16_f32 v133, -v133, v136
    v_cndmask_b32 v30, v30, v133, s[30:31]
MAIN_sequential_preLN__softmax_full_mha__glu_gated_reglu__prompt_kernel_22:
    s_waitcnt lgkmcnt(0)
    s_nop 0
    v_mfma_f32_32x32x16_bf16 v[44:59], v[108:111], v[16:19], 0
    v_mfma_f32_32x32x16_bf16 v[44:59], v[112:115], v[20:23], v[44:59]
    ds_read_b64_tr_b16 v[116:117], v34 offset:0
    s_cmp_lt_u32 s28, 4
    s_cbranch_scc1 MAINL_sequential_preLN__softmax_full_mha__glu_gated_reglu__prompt_kernel_23
    s_setprio 1
    s_nop 8
    v_mfma_f32_32x32x16_bf16 v[60:75], v[108:111], v[24:27], 0
    ds_read_b64_tr_b16 v[118:119], v34 offset:256
    s_add_u32 m0, s54, 49152
    s_add_u32 s52, s57, 4294909952
    buffer_load_dwordx4 v2, s[24:27], s52 offen offset:0 sc1 lds
    v_exp_f32 v44, v44
    v_exp_f32 v45, v45
    v_exp_f32 v46, v46
    v_exp_f32 v47, v47
    v_cvt_pk_bf16_f32 v124, v44, v45
    v_cvt_pk_bf16_f32 v125, v46, v47
    v_mfma_f32_32x32x16_bf16 v[60:75], v[112:115], v[28:31], v[60:75]
    ds_read_b128 v[108:111], v32 offset:4096
    buffer_load_dwordx4 v2, s[24:27], s52 offen offset:1024 sc1 lds
    v_exp_f32 v48, v48
    v_exp_f32 v49, v49
    v_exp_f32 v50, v50
    v_exp_f32 v51, v51
    v_cvt_pk_bf16_f32 v126, v48, v49
    v_cvt_pk_bf16_f32 v127, v50, v51
    ds_read_b128 v[112:115], v32 offset:5120
    ds_read_b64_tr_b16 v[120:121], v34 offset:512
    s_add_u32 m0, s54, 65536
    s_add_u32 s52, s57, 8192
    buffer_load_dwordx4 v2, s[24:27], s52 offen offset:0 sc1 lds
    v_exp_f32 v52, v52
    v_exp_f32 v53, v53
    v_exp_f32 v54, v54
    v_exp_f32 v55, v55
    v_cvt_pk_bf16_f32 v128, v52, v53
    v_cvt_pk_bf16_f32 v129, v54, v55
    s_waitcnt lgkmcnt(2)
    v_mfma_f32_32x32x16_bf16 v[76:91], v[116:119], v[124:127], 0
    ds_read_b64_tr_b16 v[122:123], v34 offset:768
    buffer_load_dwordx4 v2, s[24:27], s52 offen offset:1024 sc1 lds
    v_exp_f32 v56, v56
    v_exp_f32 v57, v57
    v_exp_f32 v58, v58
    v_exp_f32 v59, v59
    v_cvt_pk_bf16_f32 v130, v56, v57
    v_cvt_pk_bf16_f32 v131, v58, v59
    v_mfma_f32_32x32x16_bf16 v[44:59], v[108:111], v[16:19], 0
    s_waitcnt lgkmcnt(2)
    s_add_u32 m0, s54, 49152
    s_add_u32 s53, s57, 2037760
    buffer_load_dwordx4 v2, s[24:27], s53 offen offset:2048 sc1 lds
    v_exp_f32 v60, v60
    v_exp_f32 v61, v61
    v_exp_f32 v62, v62
    v_exp_f32 v63, v63
    v_cvt_pk_bf16_f32 v124, v60, v61
    v_cvt_pk_bf16_f32 v125, v62, v63
    v_mfma_f32_32x32x16_bf16 v[44:59], v[112:115], v[20:23], v[44:59]
    s_waitcnt lgkmcnt(0)
    buffer_load_dwordx4 v2, s[24:27], s53 offen offset:3072 sc1 lds
    v_exp_f32 v64, v64
    v_exp_f32 v65, v65
    v_exp_f32 v66, v66
    v_exp_f32 v67, v67
    v_cvt_pk_bf16_f32 v126, v64, v65
    v_cvt_pk_bf16_f32 v127, v66, v67
    v_mfma_f32_32x32x16_bf16 v[76:91], v[120:123], v[128:131], v[76:91]
    s_add_u32 m0, s54, 65536
    s_add_u32 s53, s57, 2103296
    buffer_load_dwordx4 v2, s[24:27], s53 offen offset:2048 sc1 lds
    v_exp_f32 v68, v68
    v_exp_f32 v69, v69
    v_exp_f32 v70, v70
    v_exp_f32 v71, v71
    v_cvt_pk_bf16_f32 v128, v68, v69
    v_cvt_pk_bf16_f32 v129, v70, v71
    v_mfma_f32_32x32x16_bf16 v[92:107], v[116:119], v[124:127], 0
    ds_read_b64_tr_b16 v[116:117], v34 offset:4096
    buffer_load_dwordx4 v2, s[24:27], s53 offen offset:3072 sc1 lds
    v_exp_f32 v72, v72
    v_exp_f32 v73, v73
    v_exp_f32 v74, v74
    v_exp_f32 v75, v75
    v_cvt_pk_bf16_f32 v130, v72, v73
    v_cvt_pk_bf16_f32 v131, v74, v75
    v_mfma_f32_32x32x16_bf16 v[60:75], v[108:111], v[24:27], 0
    ds_read_b64_tr_b16 v[118:119], v34 offset:4352
    s_waitcnt vmcnt(8)
    s_barrier
    s_cmp_ge_u32 s29, 2
    s_cbranch_scc0 PR_sequential_preLN__softmax_full_mha__glu_gated_reglu__prompt_kernel_25
    ds_read_b64_tr_b16 v[204:205], v239 offset:0
    ds_read_b64_tr_b16 v[206:207], v239 offset:512
    ds_read_b64_tr_b16 v[208:209], v239 offset:1024
    ds_read_b64_tr_b16 v[210:211], v239 offset:1536
    ds_read_b64_tr_b16 v[212:213], v239 offset:64
    ds_read_b64_tr_b16 v[214:215], v239 offset:576
    ds_read_b64_tr_b16 v[216:217], v239 offset:1088
    ds_read_b64_tr_b16 v[218:219], v239 offset:1600
    s_mov_b32 vcc_lo, 0
    s_mov_b32 vcc_hi, s96
    v_mov_b32 v140, 0
    s_waitcnt lgkmcnt(0)
    v_cndmask_b32 v210, v210, v140, vcc
    v_cndmask_b32 v211, v211, v140, vcc
    v_cndmask_b32 v218, v218, v140, vcc
    v_cndmask_b32 v219, v219, v140, vcc
PR_sequential_preLN__softmax_full_mha__glu_gated_reglu__prompt_kernel_25:
    v_exp_f32 v44, v44
    v_exp_f32 v45, v45
    v_exp_f32 v46, v46
    v_exp_f32 v47, v47
    v_cvt_pk_bf16_f32 v124, v44, v45
    v_cvt_pk_bf16_f32 v125, v46, v47
    v_mfma_f32_32x32x16_bf16 v[60:75], v[112:115], v[28:31], v[60:75]
    ds_read_b128 v[108:111], v32 offset:32768
    buffer_store_dwordx4 v[204:207], v236, s[24:27], s88 offen offset:0 sc1
    v_exp_f32 v48, v48
    v_exp_f32 v49, v49
    v_exp_f32 v50, v50
    v_exp_f32 v51, v51
    v_cvt_pk_bf16_f32 v126, v48, v49
    v_cvt_pk_bf16_f32 v127, v50, v51
    v_mfma_f32_32x32x16_bf16 v[92:107], v[120:123], v[128:131], v[92:107]
    ds_read_b128 v[112:115], v32 offset:33792
    ds_read_b64_tr_b16 v[120:121], v34 offset:4608
    buffer_store_dwordx4 v[208:211], v236, s[24:27], s88 offen offset:1024 sc1
    v_exp_f32 v52, v52
    v_exp_f32 v53, v53
    v_exp_f32 v54, v54
    v_exp_f32 v55, v55
    v_cvt_pk_bf16_f32 v128, v52, v53
    v_cvt_pk_bf16_f32 v129, v54, v55
    s_waitcnt lgkmcnt(2)
    v_mfma_f32_32x32x16_bf16 v[76:91], v[116:119], v[124:127], v[76:91]
    ds_read_b64_tr_b16 v[122:123], v34 offset:4864
    buffer_store_dwordx4 v[212:215], v236, s[24:27], s89 offen offset:0 sc1
    v_exp_f32 v56, v56
    v_exp_f32 v57, v57
    v_exp_f32 v58, v58
    v_exp_f32 v59, v59
    v_cvt_pk_bf16_f32 v130, v56, v57
    v_cvt_pk_bf16_f32 v131, v58, v59
    v_mfma_f32_32x32x16_bf16 v[44:59], v[108:111], v[16:19], 0
    s_waitcnt lgkmcnt(2)
    buffer_store_dwordx4 v[216:219], v236, s[24:27], s89 offen offset:1024 sc1
    v_exp_f32 v60, v60
    v_exp_f32 v61, v61
    v_exp_f32 v62, v62
    v_exp_f32 v63, v63
    v_cvt_pk_bf16_f32 v124, v60, v61
    v_cvt_pk_bf16_f32 v125, v62, v63
    v_mfma_f32_32x32x16_bf16 v[44:59], v[112:115], v[20:23], v[44:59]
    s_waitcnt lgkmcnt(0)
    s_add_u32 m0, s54, 81920
    s_add_u32 s52, s57, 4294914048
    buffer_load_dwordx4 v2, s[24:27], s52 offen offset:0 sc1 lds
    v_exp_f32 v64, v64
    v_exp_f32 v65, v65
    v_exp_f32 v66, v66
    v_exp_f32 v67, v67
    v_cvt_pk_bf16_f32 v126, v64, v65
    v_cvt_pk_bf16_f32 v127, v66, v67
    v_mfma_f32_32x32x16_bf16 v[76:91], v[120:123], v[128:131], v[76:91]
    buffer_load_dwordx4 v2, s[24:27], s52 offen offset:1024 sc1 lds
    v_exp_f32 v68, v68
    v_exp_f32 v69, v69
    v_exp_f32 v70, v70
    v_exp_f32 v71, v71
    v_cvt_pk_bf16_f32 v128, v68, v69
    v_cvt_pk_bf16_f32 v129, v70, v71
    v_mfma_f32_32x32x16_bf16 v[92:107], v[116:119], v[124:127], v[92:107]
    ds_read_b64_tr_b16 v[116:117], v34 offset:32768
    s_add_u32 m0, s54, 98304
    s_add_u32 s52, s57, 12288
    buffer_load_dwordx4 v2, s[24:27], s52 offen offset:0 sc1 lds
    v_exp_f32 v72, v72
    v_exp_f32 v73, v73
    v_exp_f32 v74, v74
    v_exp_f32 v75, v75
    v_cvt_pk_bf16_f32 v130, v72, v73
    v_cvt_pk_bf16_f32 v131, v74, v75
    v_mfma_f32_32x32x16_bf16 v[60:75], v[108:111], v[24:27], 0
    ds_read_b64_tr_b16 v[118:119], v34 offset:33024
    buffer_load_dwordx4 v2, s[24:27], s52 offen offset:1024 sc1 lds
    v_exp_f32 v44, v44
    v_exp_f32 v45, v45
    v_exp_f32 v46, v46
    v_exp_f32 v47, v47
    v_cvt_pk_bf16_f32 v124, v44, v45
    v_cvt_pk_bf16_f32 v125, v46, v47
    v_mfma_f32_32x32x16_bf16 v[60:75], v[112:115], v[28:31], v[60:75]
    ds_read_b128 v[108:111], v32 offset:36864
    s_add_u32 m0, s54, 81920
    s_add_u32 s53, s57, 2041856
    buffer_load_dwordx4 v2, s[24:27], s53 offen offset:2048 sc1 lds
    v_exp_f32 v48, v48
    v_exp_f32 v49, v49
    v_exp_f32 v50, v50
    v_exp_f32 v51, v51
    v_cvt_pk_bf16_f32 v126, v48, v49
    v_cvt_pk_bf16_f32 v127, v50, v51
    v_mfma_f32_32x32x16_bf16 v[92:107], v[120:123], v[128:131], v[92:107]
    ds_read_b128 v[112:115], v32 offset:37888
    ds_read_b64_tr_b16 v[120:121], v34 offset:33280
    buffer_load_dwordx4 v2, s[24:27], s53 offen offset:3072 sc1 lds
    v_exp_f32 v52, v52
    v_exp_f32 v53, v53
    v_exp_f32 v54, v54
    v_exp_f32 v55, v55
    v_cvt_pk_bf16_f32 v128, v52, v53
    v_cvt_pk_bf16_f32 v129, v54, v55
    s_waitcnt lgkmcnt(2)
    v_mfma_f32_32x32x16_bf16 v[76:91], v[116:119], v[124:127], v[76:91]
    ds_read_b64_tr_b16 v[122:123], v34 offset:33536
    s_add_u32 m0, s54, 98304
    s_add_u32 s53, s57, 2107392
    buffer_load_dwordx4 v2, s[24:27], s53 offen offset:2048 sc1 lds
    v_exp_f32 v56, v56
    v_exp_f32 v57, v57
    v_exp_f32 v58, v58
    v_exp_f32 v59, v59
    v_cvt_pk_bf16_f32 v130, v56, v57
    v_cvt_pk_bf16_f32 v131, v58, v59
    v_mfma_f32_32x32x16_bf16 v[44:59], v[108:111], v[16:19], 0
    s_waitcnt lgkmcnt(2)
    buffer_load_dwordx4 v2, s[24:27], s53 offen offset:3072 sc1 lds
    v_exp_f32 v60, v60
    v_exp_f32 v61, v61
    v_exp_f32 v62, v62
    v_exp_f32 v63, v63
    v_cvt_pk_bf16_f32 v124, v60, v61
    v_cvt_pk_bf16_f32 v125, v62, v63
    v_mfma_f32_32x32x16_bf16 v[44:59], v[112:115], v[20:23], v[44:59]
    s_waitcnt lgkmcnt(0)
    v_exp_f32 v64, v64
    v_exp_f32 v65, v65
    v_exp_f32 v66, v66
    v_exp_f32 v67, v67
    v_cvt_pk_bf16_f32 v126, v64, v65
    v_cvt_pk_bf16_f32 v127, v66, v67
    v_mfma_f32_32x32x16_bf16 v[76:91], v[120:123], v[128:131], v[76:91]
    v_exp_f32 v68, v68
    v_exp_f32 v69, v69
    v_exp_f32 v70, v70
    v_exp_f32 v71, v71
    v_cvt_pk_bf16_f32 v128, v68, v69
    v_cvt_pk_bf16_f32 v129, v70, v71
    v_mfma_f32_32x32x16_bf16 v[92:107], v[116:119], v[124:127], v[92:107]
    ds_read_b64_tr_b16 v[116:117], v34 offset:36864
    v_exp_f32 v72, v72
    v_exp_f32 v73, v73
    v_exp_f32 v74, v74
    v_exp_f32 v75, v75
    v_cvt_pk_bf16_f32 v130, v72, v73
    v_cvt_pk_bf16_f32 v131, v74, v75
    v_mfma_f32_32x32x16_bf16 v[60:75], v[108:111], v[24:27], 0
    ds_read_b64_tr_b16 v[118:119], v34 offset:37120
    s_waitcnt vmcnt(12)
    s_barrier
    s_waitcnt vmcnt(8)
    s_cmp_lg_u32 s56, 0
    s_cbranch_scc1 FP_sequential_preLN__softmax_full_mha__glu_gated_reglu__prompt_kernel_26
    v_mov_b32 v6, 163788
    v_mov_b32 v7, 1
    s_mov_b64 exec, 1
    ds_add_rtn_u32 v7, v6, v7
    s_waitcnt lgkmcnt(0)
    v_readfirstlane_b32 s34, v7
    s_mov_b64 exec, -1
    s_cmp_lg_u32 s34, 3
    s_cbranch_scc1 AR_sequential_preLN__softmax_full_mha__glu_gated_reglu__prompt_kernel_27
    s_lshl_b32 s34, s2, 3
    s_add_u32 s34, s34, 23691264
    v_mov_b32 v6, 0
    s_mov_b64 exec, 1
    buffer_store_dwordx2 v[4:5], v6, s[24:27], s34 offen sc1
    s_mov_b64 exec, -1
AR_sequential_preLN__softmax_full_mha__glu_gated_reglu__prompt_kernel_27:
FP_sequential_preLN__softmax_full_mha__glu_gated_reglu__prompt_kernel_26:
    s_waitcnt lgkmcnt(0)
    s_add_u32 m0, s54, 4294950912
    s_add_u32 s52, s57, 4294918144
    buffer_load_dwordx4 v2, s[24:27], s52 offen offset:0 sc1 lds
    v_exp_f32 v44, v44
    v_exp_f32 v45, v45
    v_exp_f32 v46, v46
    v_exp_f32 v47, v47
    v_cvt_pk_bf16_f32 v124, v44, v45
    v_cvt_pk_bf16_f32 v125, v46, v47
    v_mfma_f32_32x32x16_bf16 v[60:75], v[112:115], v[28:31], v[60:75]
    ds_read_b128 v[108:111], v33 offset:0
    buffer_load_dwordx4 v2, s[24:27], s52 offen offset:1024 sc1 lds
    v_exp_f32 v48, v48
    v_exp_f32 v49, v49
    v_exp_f32 v50, v50
    v_exp_f32 v51, v51
    v_cvt_pk_bf16_f32 v126, v48, v49
    v_cvt_pk_bf16_f32 v127, v50, v51
    v_mfma_f32_32x32x16_bf16 v[92:107], v[120:123], v[128:131], v[92:107]
    ds_read_b128 v[112:115], v33 offset:1024
    ds_read_b64_tr_b16 v[120:121], v34 offset:37376
    s_add_u32 m0, s54, 0
    s_add_u32 s52, s57, 16384
    buffer_load_dwordx4 v2, s[24:27], s52 offen offset:0 sc1 lds
    v_exp_f32 v52, v52
    v_exp_f32 v53, v53
    v_exp_f32 v54, v54
    v_exp_f32 v55, v55
    v_cvt_pk_bf16_f32 v128, v52, v53
    v_cvt_pk_bf16_f32 v129, v54, v55
    s_waitcnt lgkmcnt(2)
    v_mfma_f32_32x32x16_bf16 v[76:91], v[116:119], v[124:127], v[76:91]
    ds_read_b64_tr_b16 v[122:123], v34 offset:37632
    buffer_load_dwordx4 v2, s[24:27], s52 offen offset:1024 sc1 lds
    v_exp_f32 v56, v56
    v_exp_f32 v57, v57
    v_exp_f32 v58, v58
    v_exp_f32 v59, v59
    v_cvt_pk_bf16_f32 v130, v56, v57
    v_cvt_pk_bf16_f32 v131, v58, v59
    v_mfma_f32_32x32x16_bf16 v[44:59], v[108:111], v[16:19], 0
    s_waitcnt lgkmcnt(2)
    s_add_u32 m0, s54, 4294950912
    s_add_u32 s53, s57, 2045952
    buffer_load_dwordx4 v2, s[24:27], s53 offen offset:2048 sc1 lds
    v_exp_f32 v60, v60
    v_exp_f32 v61, v61
    v_exp_f32 v62, v62
    v_exp_f32 v63, v63
    v_cvt_pk_bf16_f32 v124, v60, v61
    v_cvt_pk_bf16_f32 v125, v62, v63
    v_mfma_f32_32x32x16_bf16 v[44:59], v[112:115], v[20:23], v[44:59]
    s_waitcnt lgkmcnt(0)
    buffer_load_dwordx4 v2, s[24:27], s53 offen offset:3072 sc1 lds
    v_exp_f32 v64, v64
    v_exp_f32 v65, v65
    v_exp_f32 v66, v66
    v_exp_f32 v67, v67
    v_cvt_pk_bf16_f32 v126, v64, v65
    v_cvt_pk_bf16_f32 v127, v66, v67
    v_mfma_f32_32x32x16_bf16 v[76:91], v[120:123], v[128:131], v[76:91]
    s_add_u32 m0, s54, 0
    s_add_u32 s53, s57, 2111488
    buffer_load_dwordx4 v2, s[24:27], s53 offen offset:2048 sc1 lds
    v_exp_f32 v68, v68
    v_exp_f32 v69, v69
    v_exp_f32 v70, v70
    v_exp_f32 v71, v71
    v_cvt_pk_bf16_f32 v128, v68, v69
    v_cvt_pk_bf16_f32 v129, v70, v71
    v_mfma_f32_32x32x16_bf16 v[92:107], v[116:119], v[124:127], v[92:107]
    ds_read_b64_tr_b16 v[116:117], v35 offset:0
    buffer_load_dwordx4 v2, s[24:27], s53 offen offset:3072 sc1 lds
    v_exp_f32 v72, v72
    v_exp_f32 v73, v73
    v_exp_f32 v74, v74
    v_exp_f32 v75, v75
    v_cvt_pk_bf16_f32 v130, v72, v73
    v_cvt_pk_bf16_f32 v131, v74, v75
    v_mfma_f32_32x32x16_bf16 v[60:75], v[108:111], v[24:27], 0
    ds_read_b64_tr_b16 v[118:119], v35 offset:256
    s_add_u32 m0, s86, 0
    s_nop 0
    buffer_load_dwordx4 v245, s[76:79], s39 offen lds
    v_exp_f32 v44, v44
    v_exp_f32 v45, v45
    v_exp_f32 v46, v46
    v_exp_f32 v47, v47
    v_cvt_pk_bf16_f32 v124, v44, v45
    v_cvt_pk_bf16_f32 v125, v46, v47
    v_mfma_f32_32x32x16_bf16 v[60:75], v[112:115], v[28:31], v[60:75]
    ds_read_b128 v[108:111], v33 offset:4096
    s_add_u32 m0, s85, 0
    s_nop 0
    buffer_load_dwordx4 v245, s[80:83], s39 offen lds
    s_add_u32 s39, s39, s40
    v_exp_f32 v48, v48
    v_exp_f32 v49, v49
    v_exp_f32 v50, v50
    v_exp_f32 v51, v51
    v_cvt_pk_bf16_f32 v126, v48, v49
    v_cvt_pk_bf16_f32 v127, v50, v51
    v_mfma_f32_32x32x16_bf16 v[92:107], v[120:123], v[128:131], v[92:107]
    ds_read_b128 v[112:115], v33 offset:5120
    ds_read_b64_tr_b16 v[120:121], v35 offset:512
    s_add_u32 m0, s86, 1024
    s_nop 0
    buffer_load_dwordx4 v245, s[76:79], s39 offen lds
    v_exp_f32 v52, v52
    v_exp_f32 v53, v53
    v_exp_f32 v54, v54
    v_exp_f32 v55, v55
    v_cvt_pk_bf16_f32 v128, v52, v53
    v_cvt_pk_bf16_f32 v129, v54, v55
    s_waitcnt lgkmcnt(2)
    v_mfma_f32_32x32x16_bf16 v[76:91], v[116:119], v[124:127], v[76:91]
    ds_read_b64_tr_b16 v[122:123], v35 offset:768
    s_add_u32 m0, s85, 1024
    s_nop 0
    buffer_load_dwordx4 v245, s[80:83], s39 offen lds
    s_add_u32 s39, s39, s40
    v_exp_f32 v56, v56
    v_exp_f32 v57, v57
    v_exp_f32 v58, v58
    v_exp_f32 v59, v59
    v_cvt_pk_bf16_f32 v130, v56, v57
    v_cvt_pk_bf16_f32 v131, v58, v59
    v_mfma_f32_32x32x16_bf16 v[44:59], v[108:111], v[16:19], 0
    s_waitcnt lgkmcnt(2)
    s_add_u32 m0, s86, 2048
    s_nop 0
    buffer_load_dwordx4 v245, s[76:79], s39 offen lds
    v_exp_f32 v60, v60
    v_exp_f32 v61, v61
    v_exp_f32 v62, v62
    v_exp_f32 v63, v63
    v_cvt_pk_bf16_f32 v124, v60, v61
    v_cvt_pk_bf16_f32 v125, v62, v63
    v_mfma_f32_32x32x16_bf16 v[44:59], v[112:115], v[20:23], v[44:59]
    s_waitcnt lgkmcnt(0)
    s_add_u32 m0, s85, 2048
    s_nop 0
    buffer_load_dwordx4 v245, s[80:83], s39 offen lds
    s_add_u32 s39, s39, s40
    v_exp_f32 v64, v64
    v_exp_f32 v65, v65
    v_exp_f32 v66, v66
    v_exp_f32 v67, v67
    v_cvt_pk_bf16_f32 v126, v64, v65
    v_cvt_pk_bf16_f32 v127, v66, v67
    v_mfma_f32_32x32x16_bf16 v[76:91], v[120:123], v[128:131], v[76:91]
    s_add_u32 m0, s86, 3072
    s_nop 0
    buffer_load_dwordx4 v245, s[76:79], s39 offen lds
    v_exp_f32 v68, v68
    v_exp_f32 v69, v69
    v_exp_f32 v70, v70
    v_exp_f32 v71, v71
    v_cvt_pk_bf16_f32 v128, v68, v69
    v_cvt_pk_bf16_f32 v129, v70, v71
    v_mfma_f32_32x32x16_bf16 v[92:107], v[116:119], v[124:127], v[92:107]
    ds_read_b64_tr_b16 v[116:117], v35 offset:4096
    s_add_u32 m0, s85, 3072
    s_nop 0
    buffer_load_dwordx4 v245, s[80:83], s39 offen lds
    v_exp_f32 v72, v72
    v_exp_f32 v73, v73
    v_exp_f32 v74, v74
    v_exp_f32 v75, v75
    v_cvt_pk_bf16_f32 v130, v72, v73
    v_cvt_pk_bf16_f32 v131, v74, v75
    v_mfma_f32_32x32x16_bf16 v[60:75], v[108:111], v[24:27], 0
    ds_read_b64_tr_b16 v[118:119], v35 offset:4352
    s_waitcnt vmcnt(16)
    s_barrier
    v_exp_f32 v44, v44
    v_exp_f32 v45, v45
    v_exp_f32 v46, v46
    v_exp_f32 v47, v47
    v_cvt_pk_bf16_f32 v124, v44, v45
    v_cvt_pk_bf16_f32 v125, v46, v47
    v_mfma_f32_32x32x16_bf16 v[60:75], v[112:115], v[28:31], v[60:75]
    ds_read_b128 v[108:111], v33 offset:32768
    v_exp_f32 v48, v48
    v_exp_f32 v49, v49
    v_exp_f32 v50, v50
    v_exp_f32 v51, v51
    v_cvt_pk_bf16_f32 v126, v48, v49
    v_cvt_pk_bf16_f32 v127, v50, v51
    v_mfma_f32_32x32x16_bf16 v[92:107], v[120:123], v[128:131], v[92:107]
    ds_read_b128 v[112:115], v33 offset:33792
    ds_read_b64_tr_b16 v[120:121], v35 offset:4608
    v_exp_f32 v52, v52
    v_exp_f32 v53, v53
    v_exp_f32 v54, v54
    v_exp_f32 v55, v55
    v_cvt_pk_bf16_f32 v128, v52, v53
    v_cvt_pk_bf16_f32 v129, v54, v55
    s_waitcnt lgkmcnt(2)
    v_mfma_f32_32x32x16_bf16 v[76:91], v[116:119], v[124:127], v[76:91]
    ds_read_b64_tr_b16 v[122:123], v35 offset:4864
    v_exp_f32 v56, v56
    v_exp_f32 v57, v57
    v_exp_f32 v58, v58
    v_exp_f32 v59, v59
    v_cvt_pk_bf16_f32 v130, v56, v57
    v_cvt_pk_bf16_f32 v131, v58, v59
    v_mfma_f32_32x32x16_bf16 v[44:59], v[108:111], v[16:19], 0
    s_waitcnt lgkmcnt(2)
    v_exp_f32 v60, v60
    v_exp_f32 v61, v61
    v_exp_f32 v62, v62
    v_exp_f32 v63, v63
    v_cvt_pk_bf16_f32 v124, v60, v61
    v_cvt_pk_bf16_f32 v125, v62, v63
    v_mfma_f32_32x32x16_bf16 v[44:59], v[112:115], v[20:23], v[44:59]
    s_waitcnt lgkmcnt(0)
    v_exp_f32 v64, v64
    v_exp_f32 v65, v65
    v_exp_f32 v66, v66
    v_exp_f32 v67, v67
    v_cvt_pk_bf16_f32 v126, v64, v65
    v_cvt_pk_bf16_f32 v127, v66, v67
    v_mfma_f32_32x32x16_bf16 v[76:91], v[120:123], v[128:131], v[76:91]
    s_add_u32 m0, s54, 16384
    s_add_u32 s52, s57, 4294922240
    buffer_load_dwordx4 v2, s[24:27], s52 offen offset:0 sc1 lds
    v_exp_f32 v68, v68
    v_exp_f32 v69, v69
    v_exp_f32 v70, v70
    v_exp_f32 v71, v71
    v_cvt_pk_bf16_f32 v128, v68, v69
    v_cvt_pk_bf16_f32 v129, v70, v71
    v_mfma_f32_32x32x16_bf16 v[92:107], v[116:119], v[124:127], v[92:107]
    ds_read_b64_tr_b16 v[116:117], v35 offset:32768
    buffer_load_dwordx4 v2, s[24:27], s52 offen offset:1024 sc1 lds
    v_exp_f32 v72, v72
    v_exp_f32 v73, v73
    v_exp_f32 v74, v74
    v_exp_f32 v75, v75
    v_cvt_pk_bf16_f32 v130, v72, v73
    v_cvt_pk_bf16_f32 v131, v74, v75
    v_mfma_f32_32x32x16_bf16 v[60:75], v[108:111], v[24:27], 0
    ds_read_b64_tr_b16 v[118:119], v35 offset:33024
    s_add_u32 m0, s54, 32768
    s_add_u32 s52, s57, 20480
    buffer_load_dwordx4 v2, s[24:27], s52 offen offset:0 sc1 lds
    v_exp_f32 v44, v44
    v_exp_f32 v45, v45
    v_exp_f32 v46, v46
    v_exp_f32 v47, v47
    v_cvt_pk_bf16_f32 v124, v44, v45
    v_cvt_pk_bf16_f32 v125, v46, v47
    v_mfma_f32_32x32x16_bf16 v[60:75], v[112:115], v[28:31], v[60:75]
    ds_read_b128 v[108:111], v33 offset:36864
    buffer_load_dwordx4 v2, s[24:27], s52 offen offset:1024 sc1 lds
    v_exp_f32 v48, v48
    v_exp_f32 v49, v49
    v_exp_f32 v50, v50
    v_exp_f32 v51, v51
    v_cvt_pk_bf16_f32 v126, v48, v49
    v_cvt_pk_bf16_f32 v127, v50, v51
    v_mfma_f32_32x32x16_bf16 v[92:107], v[120:123], v[128:131], v[92:107]
    ds_read_b128 v[112:115], v33 offset:37888
    ds_read_b64_tr_b16 v[120:121], v35 offset:33280
    s_add_u32 m0, s54, 16384
    s_add_u32 s53, s57, 2050048
    buffer_load_dwordx4 v2, s[24:27], s53 offen offset:2048 sc1 lds
    v_exp_f32 v52, v52
    v_exp_f32 v53, v53
    v_exp_f32 v54, v54
    v_exp_f32 v55, v55
    v_cvt_pk_bf16_f32 v128, v52, v53
    v_cvt_pk_bf16_f32 v129, v54, v55
    s_waitcnt lgkmcnt(2)
    v_mfma_f32_32x32x16_bf16 v[76:91], v[116:119], v[124:127], v[76:91]
    ds_read_b64_tr_b16 v[122:123], v35 offset:33536
    buffer_load_dwordx4 v2, s[24:27], s53 offen offset:3072 sc1 lds
    v_exp_f32 v56, v56
    v_exp_f32 v57, v57
    v_exp_f32 v58, v58
    v_exp_f32 v59, v59
    v_cvt_pk_bf16_f32 v130, v56, v57
    v_cvt_pk_bf16_f32 v131, v58, v59
    v_mfma_f32_32x32x16_bf16 v[44:59], v[108:111], v[16:19], 0
    s_waitcnt lgkmcnt(2)
    s_add_u32 m0, s54, 32768
    s_add_u32 s53, s57, 2115584
    buffer_load_dwordx4 v2, s[24:27], s53 offen offset:2048 sc1 lds
    v_exp_f32 v60, v60
    v_exp_f32 v61, v61
    v_exp_f32 v62, v62
    v_exp_f32 v63, v63
    v_cvt_pk_bf16_f32 v124, v60, v61
    v_cvt_pk_bf16_f32 v125, v62, v63
    v_mfma_f32_32x32x16_bf16 v[44:59], v[112:115], v[20:23], v[44:59]
    s_waitcnt lgkmcnt(0)
    buffer_load_dwordx4 v2, s[24:27], s53 offen offset:3072 sc1 lds
    v_exp_f32 v64, v64
    v_exp_f32 v65, v65
    v_exp_f32 v66, v66
    v_exp_f32 v67, v67
    v_cvt_pk_bf16_f32 v126, v64, v65
    v_cvt_pk_bf16_f32 v127, v66, v67
    v_mfma_f32_32x32x16_bf16 v[76:91], v[120:123], v[128:131], v[76:91]
    s_cmp_lg_u32 s28, 7
    s_cbranch_scc1 FL_sequential_preLN__softmax_full_mha__glu_gated_reglu__prompt_kernel_28
    s_mov_b32 s35, 23691264
    buffer_load_dwordx4 v[244:247], v2, s[24:27], s35 offen sc1
    buffer_load_dwordx4 v[248:251], v2, s[24:27], s35 offen offset:1024 sc1
FL_sequential_preLN__softmax_full_mha__glu_gated_reglu__prompt_kernel_28:
    v_exp_f32 v68, v68
    v_exp_f32 v69, v69
    v_exp_f32 v70, v70
    v_exp_f32 v71, v71
    v_cvt_pk_bf16_f32 v128, v68, v69
    v_cvt_pk_bf16_f32 v129, v70, v71
    v_mfma_f32_32x32x16_bf16 v[92:107], v[116:119], v[124:127], v[92:107]
    ds_read_b64_tr_b16 v[116:117], v35 offset:36864
    v_exp_f32 v72, v72
    v_exp_f32 v73, v73
    v_exp_f32 v74, v74
    v_exp_f32 v75, v75
    v_cvt_pk_bf16_f32 v130, v72, v73
    v_cvt_pk_bf16_f32 v131, v74, v75
    v_mfma_f32_32x32x16_bf16 v[60:75], v[108:111], v[24:27], 0
    ds_read_b64_tr_b16 v[118:119], v35 offset:37120
    s_waitcnt vmcnt(16)
    s_barrier
    s_cmp_lg_u32 s28, 7
    s_cbranch_scc1 FX_sequential_preLN__softmax_full_mha__glu_gated_reglu__prompt_kernel_29
    s_mov_b32 s34, 0
FC_sequential_preLN__softmax_full_mha__glu_gated_reglu__prompt_kernel_30:
    s_waitcnt vmcnt(0)
    v_cmp_ne_u64 vcc, v[244:245], v[4:5]
    v_cmp_ne_u64 s[36:37], v[246:247], v[4:5]
    s_nop 0
    s_or_b64 vcc, vcc, s[36:37]
    v_cmp_ne_u64 s[36:37], v[248:249], v[4:5]
    s_nop 0
    s_or_b64 vcc, vcc, s[36:37]
    v_cmp_ne_u64 s[36:37], v[250:251], v[4:5]
    s_nop 0
    s_or_b64 vcc, vcc, s[36:37]
    s_cbranch_scc0 FX_sequential_preLN__softmax_full_mha__glu_gated_reglu__prompt_kernel_29
    s_add_u32 s34, s34, 1
    s_cmp_gt_u32 s34, 65536
    s_cbranch_scc1 FX_sequential_preLN__softmax_full_mha__glu_gated_reglu__prompt_kernel_29
    s_sleep 8
    s_mov_b32 s35, 23691264
    buffer_load_dwordx4 v[244:247], v2, s[24:27], s35 offen sc1
    buffer_load_dwordx4 v[248:251], v2, s[24:27], s35 offen offset:1024 sc1
    s_branch FC_sequential_preLN__softmax_full_mha__glu_gated_reglu__prompt_kernel_30
FX_sequential_preLN__softmax_full_mha__glu_gated_reglu__prompt_kernel_29:
    s_waitcnt vmcnt(8)
    s_cmp_ge_u32 s29, 2
    s_cbranch_scc1 PR_sequential_preLN__softmax_full_mha__glu_gated_reglu__prompt_kernel_31
    ds_read_b64_tr_b16 v[204:205], v239 offset:0
    ds_read_b64_tr_b16 v[206:207], v239 offset:512
    ds_read_b64_tr_b16 v[208:209], v239 offset:2048
    ds_read_b64_tr_b16 v[210:211], v239 offset:2560
    ds_read_b64_tr_b16 v[212:213], v239 offset:16
    ds_read_b64_tr_b16 v[214:215], v239 offset:528
    ds_read_b64_tr_b16 v[216:217], v239 offset:2064
    ds_read_b64_tr_b16 v[218:219], v239 offset:2576
    ds_read_b64_tr_b16 v[220:221], v239 offset:64
    ds_read_b64_tr_b16 v[222:223], v239 offset:576
    ds_read_b64_tr_b16 v[224:225], v239 offset:2112
    ds_read_b64_tr_b16 v[226:227], v239 offset:2624
    ds_read_b64_tr_b16 v[228:229], v239 offset:80
    ds_read_b64_tr_b16 v[230:231], v239 offset:592
    ds_read_b64_tr_b16 v[232:233], v239 offset:2128
    ds_read_b64_tr_b16 v[234:235], v239 offset:2640
    s_waitcnt lgkmcnt(12)
    v_mfma_f32_32x32x16_bf16 v[140:155], v[240:243], v[204:207], 0
    v_mfma_f32_32x32x16_bf16 v[140:155], v[240:243], v[208:211], v[140:155]
    s_waitcnt lgkmcnt(8)
    v_mfma_f32_32x32x16_bf16 v[156:171], v[240:243], v[212:215], 0
    v_mfma_f32_32x32x16_bf16 v[156:171], v[240:243], v[216:219], v[156:171]
    s_waitcnt lgkmcnt(4)
    v_mfma_f32_32x32x16_bf16 v[172:187], v[240:243], v[220:223], 0
    v_mfma_f32_32x32x16_bf16 v[172:187], v[240:243], v[224:227], v[172:187]
    s_waitcnt lgkmcnt(0)
    v_mfma_f32_32x32x16_bf16 v[188:203], v[240:243], v[228:231], 0
    v_mfma_f32_32x32x16_bf16 v[188:203], v[240:243], v[232:235], v[188:203]
PR_sequential_preLN__softmax_full_mha__glu_gated_reglu__prompt_kernel_31:
    v_exp_f32 v44, v44
    v_exp_f32 v45, v45
    v_exp_f32 v46, v46
    v_exp_f32 v47, v47
    v_cvt_pk_bf16_f32 v124, v44, v45
    v_cvt_pk_bf16_f32 v125, v46, v47
    v_mfma_f32_32x32x16_bf16 v[60:75], v[112:115], v[28:31], v[60:75]
    ds_read_b128 v[108:111], v32 offset:0
    buffer_store_dwordx4 v[204:207], v237, s[24:27], s88 offen offset:0 sc1
    buffer_store_dwordx4 v[208:211], v237, s[24:27], s88 offen offset:1024 sc1
    v_exp_f32 v48, v48
    v_exp_f32 v49, v49
    v_exp_f32 v50, v50
    v_exp_f32 v51, v51
    v_cvt_pk_bf16_f32 v126, v48, v49
    v_cvt_pk_bf16_f32 v127, v50, v51
    v_mfma_f32_32x32x16_bf16 v[92:107], v[120:123], v[128:131], v[92:107]
    ds_read_b128 v[112:115], v32 offset:1024
    ds_read_b64_tr_b16 v[120:121], v35 offset:37376
    buffer_store_dwordx4 v[212:215], v237, s[24:27], s89 offen offset:0 sc1
    buffer_store_dwordx4 v[216:219], v237, s[24:27], s89 offen offset:1024 sc1
    v_exp_f32 v52, v52
    v_exp_f32 v53, v53
    v_exp_f32 v54, v54
    v_exp_f32 v55, v55
    v_cvt_pk_bf16_f32 v128, v52, v53
    v_cvt_pk_bf16_f32 v129, v54, v55
    s_waitcnt lgkmcnt(2)
    v_mfma_f32_32x32x16_bf16 v[76:91], v[116:119], v[124:127], v[76:91]
    ds_read_b64_tr_b16 v[122:123], v35 offset:37632
    buffer_store_dwordx4 v[220:223], v237, s[24:27], s90 offen offset:0 sc1
    buffer_store_dwordx4 v[224:227], v237, s[24:27], s90 offen offset:1024 sc1
    v_exp_f32 v56, v56
    v_exp_f32 v57, v57
    v_exp_f32 v58, v58
    v_exp_f32 v59, v59
    v_cvt_pk_bf16_f32 v130, v56, v57
    v_cvt_pk_bf16_f32 v131, v58, v59
    v_mfma_f32_32x32x16_bf16 v[44:59], v[108:111], v[16:19], 0
    s_waitcnt lgkmcnt(2)
    buffer_store_dwordx4 v[228:231], v237, s[24:27], s91 offen offset:0 sc1
    v_exp_f32 v60, v60
    v_exp_f32 v61, v61
    v_exp_f32 v62, v62
    v_exp_f32 v63, v63
    v_cvt_pk_bf16_f32 v124, v60, v61
    v_cvt_pk_bf16_f32 v125, v62, v63
    v_mfma_f32_32x32x16_bf16 v[44:59], v[112:115], v[20:23], v[44:59]
    s_waitcnt lgkmcnt(0)
    buffer_store_dwordx4 v[232:235], v237, s[24:27], s91 offen offset:1024 sc1
    v_exp_f32 v64, v64
    v_exp_f32 v65, v65
    v_exp_f32 v66, v66
    v_exp_f32 v67, v67
    v_cvt_pk_bf16_f32 v126, v64, v65
    v_cvt_pk_bf16_f32 v127, v66, v67
    v_mfma_f32_32x32x16_bf16 v[76:91], v[120:123], v[128:131], v[76:91]
    s_mov_b32 exec_hi, 0
    buffer_store_dword v140, v238, s[24:27], s92 offen sc1
    buffer_store_dword v156, v238, s[24:27], s93 offen sc1
    s_mov_b32 exec_hi, -1
    v_exp_f32 v68, v68
    v_exp_f32 v69, v69
    v_exp_f32 v70, v70
    v_exp_f32 v71, v71
    v_cvt_pk_bf16_f32 v128, v68, v69
    v_cvt_pk_bf16_f32 v129, v70, v71
    v_mfma_f32_32x32x16_bf16 v[92:107], v[116:119], v[124:127], v[92:107]
    ds_read_b64_tr_b16 v[116:117], v34 offset:0
    s_mov_b32 exec_hi, 0
    buffer_store_dword v172, v238, s[24:27], s94 offen sc1
    buffer_store_dword v188, v238, s[24:27], s95 offen sc1
    s_mov_b32 exec_hi, -1
    v_exp_f32 v72, v72
    v_exp_f32 v73, v73
    v_exp_f32 v74, v74
    v_exp_f32 v75, v75
    v_cvt_pk_bf16_f32 v130, v72, v73
    v_cvt_pk_bf16_f32 v131, v74, v75
    v_mfma_f32_32x32x16_bf16 v[60:75], v[108:111], v[24:27], 0
    ds_read_b64_tr_b16 v[118:119], v34 offset:256
    s_add_u32 m0, s54, 49152
    s_add_u32 s52, s57, 4294926336
    buffer_load_dwordx4 v2, s[24:27], s52 offen offset:0 sc1 lds
    v_exp_f32 v44, v44
    v_exp_f32 v45, v45
    v_exp_f32 v46, v46
    v_exp_f32 v47, v47
    v_cvt_pk_bf16_f32 v124, v44, v45
    v_cvt_pk_bf16_f32 v125, v46, v47
    v_mfma_f32_32x32x16_bf16 v[60:75], v[112:115], v[28:31], v[60:75]
    ds_read_b128 v[108:111], v32 offset:4096
    buffer_load_dwordx4 v2, s[24:27], s52 offen offset:1024 sc1 lds
    v_exp_f32 v48, v48
    v_exp_f32 v49, v49
    v_exp_f32 v50, v50
    v_exp_f32 v51, v51
    v_cvt_pk_bf16_f32 v126, v48, v49
    v_cvt_pk_bf16_f32 v127, v50, v51
    v_mfma_f32_32x32x16_bf16 v[92:107], v[120:123], v[128:131], v[92:107]
    ds_read_b128 v[112:115], v32 offset:5120
    ds_read_b64_tr_b16 v[120:121], v34 offset:512
    s_add_u32 m0, s54, 65536
    s_add_u32 s52, s57, 24576
    buffer_load_dwordx4 v2, s[24:27], s52 offen offset:0 sc1 lds
    v_exp_f32 v52, v52
    v_exp_f32 v53, v53
    v_exp_f32 v54, v54
    v_exp_f32 v55, v55
    v_cvt_pk_bf16_f32 v128, v52, v53
    v_cvt_pk_bf16_f32 v129, v54, v55
    s_waitcnt lgkmcnt(2)
    v_mfma_f32_32x32x16_bf16 v[76:91], v[116:119], v[124:127], v[76:91]
    ds_read_b64_tr_b16 v[122:123], v34 offset:768
    buffer_load_dwordx4 v2, s[24:27], s52 offen offset:1024 sc1 lds
    v_exp_f32 v56, v56
    v_exp_f32 v57, v57
    v_exp_f32 v58, v58
    v_exp_f32 v59, v59
    v_cvt_pk_bf16_f32 v130, v56, v57
    v_cvt_pk_bf16_f32 v131, v58, v59
    v_mfma_f32_32x32x16_bf16 v[44:59], v[108:111], v[16:19], 0
    s_waitcnt lgkmcnt(2)
    s_add_u32 m0, s54, 49152
    s_add_u32 s53, s57, 2054144
    buffer_load_dwordx4 v2, s[24:27], s53 offen offset:2048 sc1 lds
    v_exp_f32 v60, v60
    v_exp_f32 v61, v61
    v_exp_f32 v62, v62
    v_exp_f32 v63, v63
    v_cvt_pk_bf16_f32 v124, v60, v61
    v_cvt_pk_bf16_f32 v125, v62, v63
    v_mfma_f32_32x32x16_bf16 v[44:59], v[112:115], v[20:23], v[44:59]
    s_waitcnt lgkmcnt(0)
    buffer_load_dwordx4 v2, s[24:27], s53 offen offset:3072 sc1 lds
    v_exp_f32 v64, v64
    v_exp_f32 v65, v65
    v_exp_f32 v66, v66
    v_exp_f32 v67, v67
    v_cvt_pk_bf16_f32 v126, v64, v65
    v_cvt_pk_bf16_f32 v127, v66, v67
    v_mfma_f32_32x32x16_bf16 v[76:91], v[120:123], v[128:131], v[76:91]
    s_add_u32 m0, s54, 65536
    s_add_u32 s53, s57, 2119680
    buffer_load_dwordx4 v2, s[24:27], s53 offen offset:2048 sc1 lds
    v_exp_f32 v68, v68
    v_exp_f32 v69, v69
    v_exp_f32 v70, v70
    v_exp_f32 v71, v71
    v_cvt_pk_bf16_f32 v128, v68, v69
    v_cvt_pk_bf16_f32 v129, v70, v71
    v_mfma_f32_32x32x16_bf16 v[92:107], v[116:119], v[124:127], v[92:107]
    ds_read_b64_tr_b16 v[116:117], v34 offset:4096
    buffer_load_dwordx4 v2, s[24:27], s53 offen offset:3072 sc1 lds
    v_exp_f32 v72, v72
    v_exp_f32 v73, v73
    v_exp_f32 v74, v74
    v_exp_f32 v75, v75
    v_cvt_pk_bf16_f32 v130, v72, v73
    v_cvt_pk_bf16_f32 v131, v74, v75
    v_mfma_f32_32x32x16_bf16 v[60:75], v[108:111], v[24:27], 0
    ds_read_b64_tr_b16 v[118:119], v34 offset:4352
    s_waitcnt vmcnt(20)
    s_barrier
    s_add_u32 m0, s54, 81920
    s_add_u32 s52, s57, 4294930432
    buffer_load_dwordx4 v2, s[24:27], s52 offen offset:0 sc1 lds
    buffer_load_dwordx4 v2, s[24:27], s52 offen offset:1024 sc1 lds
    v_exp_f32 v44, v44
    v_exp_f32 v45, v45
    v_exp_f32 v46, v46
    v_exp_f32 v47, v47
    v_cvt_pk_bf16_f32 v124, v44, v45
    v_cvt_pk_bf16_f32 v125, v46, v47
    v_mfma_f32_32x32x16_bf16 v[60:75], v[112:115], v[28:31], v[60:75]
    ds_read_b128 v[108:111], v32 offset:32768
    s_add_u32 m0, s54, 98304
    s_add_u32 s52, s57, 28672
    buffer_load_dwordx4 v2, s[24:27], s52 offen offset:0 sc1 lds
    v_exp_f32 v48, v48
    v_exp_f32 v49, v49
    v_exp_f32 v50, v50
    v_exp_f32 v51, v51
    v_cvt_pk_bf16_f32 v126, v48, v49
    v_cvt_pk_bf16_f32 v127, v50, v51
    v_mfma_f32_32x32x16_bf16 v[92:107], v[120:123], v[128:131], v[92:107]
    ds_read_b128 v[112:115], v32 offset:33792
    ds_read_b64_tr_b16 v[120:121], v34 offset:4608
    buffer_load_dwordx4 v2, s[24:27], s52 offen offset:1024 sc1 lds
    v_exp_f32 v52, v52
    v_exp_f32 v53, v53
    v_exp_f32 v54, v54
    v_exp_f32 v55, v55
    v_cvt_pk_bf16_f32 v128, v52, v53
    v_cvt_pk_bf16_f32 v129, v54, v55
    s_waitcnt lgkmcnt(2)
    v_mfma_f32_32x32x16_bf16 v[76:91], v[116:119], v[124:127], v[76:91]
    ds_read_b64_tr_b16 v[122:123], v34 offset:4864
    s_add_u32 m0, s54, 81920
    s_add_u32 s53, s57, 2058240
    buffer_load_dwordx4 v2, s[24:27], s53 offen offset:2048 sc1 lds
    v_exp_f32 v56, v56
    v_exp_f32 v57, v57
    v_exp_f32 v58, v58
    v_exp_f32 v59, v59
    v_cvt_pk_bf16_f32 v130, v56, v57
    v_cvt_pk_bf16_f32 v131, v58, v59
    v_mfma_f32_32x32x16_bf16 v[44:59], v[108:111], v[16:19], 0
    s_waitcnt lgkmcnt(2)
    buffer_load_dwordx4 v2, s[24:27], s53 offen offset:3072 sc1 lds
    v_exp_f32 v60, v60
    v_exp_f32 v61, v61
    v_exp_f32 v62, v62
    v_exp_f32 v63, v63
    v_cvt_pk_bf16_f32 v124, v60, v61
    v_cvt_pk_bf16_f32 v125, v62, v63
    v_mfma_f32_32x32x16_bf16 v[44:59], v[112:115], v[20:23], v[44:59]
    s_waitcnt lgkmcnt(0)
    s_add_u32 m0, s54, 98304
    s_add_u32 s53, s57, 2123776
    buffer_load_dwordx4 v2, s[24:27], s53 offen offset:2048 sc1 lds
    v_exp_f32 v64, v64
    v_exp_f32 v65, v65
    v_exp_f32 v66, v66
    v_exp_f32 v67, v67
    v_cvt_pk_bf16_f32 v126, v64, v65
    v_cvt_pk_bf16_f32 v127, v66, v67
    v_mfma_f32_32x32x16_bf16 v[76:91], v[120:123], v[128:131], v[76:91]
    buffer_load_dwordx4 v2, s[24:27], s53 offen offset:3072 sc1 lds
    v_exp_f32 v68, v68
    v_exp_f32 v69, v69
    v_exp_f32 v70, v70
    v_exp_f32 v71, v71
    v_cvt_pk_bf16_f32 v128, v68, v69
    v_cvt_pk_bf16_f32 v129, v70, v71
    v_mfma_f32_32x32x16_bf16 v[92:107], v[116:119], v[124:127], v[92:107]
    ds_read_b64_tr_b16 v[116:117], v34 offset:32768
    s_lshr_b32 s34, s2, 5
    s_min_u32 s34, s34, 6
    s_lshl_b32 s64, s34, 3
    s_add_u32 s64, s64, s28
    s_mul_i32 s64, s64, 28672
    s_add_u32 s64, s64, 18022400
    s_mov_b32 s65, 0
    s_and_b32 s34, s29, 1
    s_lshl_b32 s34, s34, 8
    v_xor_b32 v137, s34, v2
    s_lshr_b32 s34, s2, 5
    s_lshl_b32 s34, s34, 3
    s_add_u32 s34, s34, s29
    s_lshl_b32 s34, s34, 13
    s_add_u32 s66, s34, 17563648
    v_exp_f32 v72, v72
    v_exp_f32 v73, v73
    v_exp_f32 v74, v74
    v_exp_f32 v75, v75
    v_cvt_pk_bf16_f32 v130, v72, v73
    v_cvt_pk_bf16_f32 v131, v74, v75
    v_mfma_f32_32x32x16_bf16 v[60:75], v[108:111], v[24:27], 0
    ds_read_b64_tr_b16 v[118:119], v34 offset:33024
    s_lshl_b32 s67, s65, 12
    s_add_u32 s67, s67, s64
    buffer_load_dwordx4 v[140:143], v137, s[24:27], s67 offen offset:0 sc1
    v_exp_f32 v44, v44
    v_exp_f32 v45, v45
    v_exp_f32 v46, v46
    v_exp_f32 v47, v47
    v_cvt_pk_bf16_f32 v124, v44, v45
    v_cvt_pk_bf16_f32 v125, v46, v47
    v_mfma_f32_32x32x16_bf16 v[60:75], v[112:115], v[28:31], v[60:75]
    ds_read_b128 v[108:111], v32 offset:36864
    buffer_load_dwordx4 v[144:147], v137, s[24:27], s67 offen offset:1024 sc1
    s_add_u32 s65, s65, 1
    s_cmp_eq_u32 s65, 7
    s_cselect_b32 s65, 0, s65
    v_exp_f32 v48, v48
    v_exp_f32 v49, v49
    v_exp_f32 v50, v50
    v_exp_f32 v51, v51
    v_cvt_pk_bf16_f32 v126, v48, v49
    v_cvt_pk_bf16_f32 v127, v50, v51
    v_mfma_f32_32x32x16_bf16 v[92:107], v[120:123], v[128:131], v[92:107]
    ds_read_b128 v[112:115], v32 offset:37888
    ds_read_b64_tr_b16 v[120:121], v34 offset:33280
    buffer_load_dwordx4 v[148:151], v137, s[24:27], s67 offen offset:2048 sc1
    v_exp_f32 v52, v52
    v_exp_f32 v53, v53
    v_exp_f32 v54, v54
    v_exp_f32 v55, v55
    v_cvt_pk_bf16_f32 v128, v52, v53
    v_cvt_pk_bf16_f32 v129, v54, v55
    s_waitcnt lgkmcnt(2)
    v_mfma_f32_32x32x16_bf16 v[76:91], v[116:119], v[124:127], v[76:91]
    ds_read_b64_tr_b16 v[122:123], v34 offset:33536
    buffer_load_dwordx4 v[152:155], v137, s[24:27], s67 offen offset:3072 sc1
    v_exp_f32 v56, v56
    v_exp_f32 v57, v57
    v_exp_f32 v58, v58
    v_exp_f32 v59, v59
    v_cvt_pk_bf16_f32 v130, v56, v57
    v_cvt_pk_bf16_f32 v131, v58, v59
    v_mfma_f32_32x32x16_bf16 v[44:59], v[108:111], v[16:19], 0
    s_waitcnt lgkmcnt(2)
    s_lshl_b32 s67, s65, 12
    s_add_u32 s67, s67, s64
    buffer_load_dwordx4 v[156:159], v137, s[24:27], s67 offen offset:0 sc1
    v_exp_f32 v60, v60
    v_exp_f32 v61, v61
    v_exp_f32 v62, v62
    v_exp_f32 v63, v63
    v_cvt_pk_bf16_f32 v124, v60, v61
    v_cvt_pk_bf16_f32 v125, v62, v63
    v_mfma_f32_32x32x16_bf16 v[44:59], v[112:115], v[20:23], v[44:59]
    s_waitcnt lgkmcnt(0)
    buffer_load_dwordx4 v[160:163], v137, s[24:27], s67 offen offset:1024 sc1
    s_add_u32 s65, s65, 1
    s_cmp_eq_u32 s65, 7
    s_cselect_b32 s65, 0, s65
    v_exp_f32 v64, v64
    v_exp_f32 v65, v65
    v_exp_f32 v66, v66
    v_exp_f32 v67, v67
    v_cvt_pk_bf16_f32 v126, v64, v65
    v_cvt_pk_bf16_f32 v127, v66, v67
    v_mfma_f32_32x32x16_bf16 v[76:91], v[120:123], v[128:131], v[76:91]
    buffer_load_dwordx4 v[164:167], v137, s[24:27], s67 offen offset:2048 sc1
    v_exp_f32 v68, v68
    v_exp_f32 v69, v69
    v_exp_f32 v70, v70
    v_exp_f32 v71, v71
    v_cvt_pk_bf16_f32 v128, v68, v69
    v_cvt_pk_bf16_f32 v129, v70, v71
    v_mfma_f32_32x32x16_bf16 v[92:107], v[116:119], v[124:127], v[92:107]
    ds_read_b64_tr_b16 v[116:117], v34 offset:36864
    buffer_load_dwordx4 v[168:171], v137, s[24:27], s67 offen offset:3072 sc1
    v_exp_f32 v72, v72
    v_exp_f32 v73, v73
    v_exp_f32 v74, v74
    v_exp_f32 v75, v75
    v_cvt_pk_bf16_f32 v130, v72, v73
    v_cvt_pk_bf16_f32 v131, v74, v75
    v_mfma_f32_32x32x16_bf16 v[60:75], v[108:111], v[24:27], 0
    ds_read_b64_tr_b16 v[118:119], v34 offset:37120
    s_waitcnt vmcnt(16)
    s_barrier
    s_cmp_lg_u32 s56, 0
    s_cbranch_scc1 FP_sequential_preLN__softmax_full_mha__glu_gated_reglu__prompt_kernel_32
    v_mov_b32 v6, 163792
    v_mov_b32 v7, 1
    s_mov_b64 exec, 1
    ds_add_rtn_u32 v7, v6, v7
    s_waitcnt lgkmcnt(0)
    v_readfirstlane_b32 s34, v7
    s_mov_b64 exec, -1
    s_cmp_lg_u32 s34, 3
    s_cbranch_scc1 AR_sequential_preLN__softmax_full_mha__glu_gated_reglu__prompt_kernel_33
    s_lshl_b32 s34, s2, 3
    s_add_u32 s34, s34, 23695360
    v_mov_b32 v6, 0
    s_mov_b64 exec, 1
    buffer_store_dwordx2 v[4:5], v6, s[24:27], s34 offen sc1
    s_mov_b64 exec, -1
AR_sequential_preLN__softmax_full_mha__glu_gated_reglu__prompt_kernel_33:
FP_sequential_preLN__softmax_full_mha__glu_gated_reglu__prompt_kernel_32:
    s_waitcnt lgkmcnt(0)
    s_add_u32 m0, s54, 4294950912
    s_add_u32 s34, s66, 0
    buffer_load_dwordx4 v2, s[24:27], s34 offen offset:0 sc1 lds
    v_exp_f32 v44, v44
    v_exp_f32 v45, v45
    v_exp_f32 v46, v46
    v_exp_f32 v47, v47
    v_cvt_pk_bf16_f32 v124, v44, v45
    v_cvt_pk_bf16_f32 v125, v46, v47
    v_mfma_f32_32x32x16_bf16 v[60:75], v[112:115], v[28:31], v[60:75]
    ds_read_b128 v[108:111], v33 offset:0
    buffer_load_dwordx4 v2, s[24:27], s34 offen offset:1024 sc1 lds
    buffer_load_dwordx4 v2, s[24:27], s34 offen offset:2048 sc1 lds
    v_exp_f32 v48, v48
    v_exp_f32 v49, v49
    v_exp_f32 v50, v50
    v_exp_f32 v51, v51
    v_cvt_pk_bf16_f32 v126, v48, v49
    v_cvt_pk_bf16_f32 v127, v50, v51
    v_mfma_f32_32x32x16_bf16 v[92:107], v[120:123], v[128:131], v[92:107]
    ds_read_b128 v[112:115], v33 offset:1024
    ds_read_b64_tr_b16 v[120:121], v34 offset:37376
    buffer_load_dwordx4 v2, s[24:27], s34 offen offset:3072 sc1 lds
    s_add_u32 m0, s54, 0
    s_add_u32 s34, s66, 32768
    buffer_load_dwordx4 v2, s[24:27], s34 offen offset:0 sc1 lds
    v_exp_f32 v52, v52
    v_exp_f32 v53, v53
    v_exp_f32 v54, v54
    v_exp_f32 v55, v55
    v_cvt_pk_bf16_f32 v128, v52, v53
    v_cvt_pk_bf16_f32 v129, v54, v55
    s_waitcnt lgkmcnt(2)
    v_mfma_f32_32x32x16_bf16 v[76:91], v[116:119], v[124:127], v[76:91]
    ds_read_b64_tr_b16 v[122:123], v34 offset:37632
    buffer_load_dwordx4 v2, s[24:27], s34 offen offset:1024 sc1 lds
    buffer_load_dwordx4 v2, s[24:27], s34 offen offset:2048 sc1 lds
    v_exp_f32 v56, v56
    v_exp_f32 v57, v57
    v_exp_f32 v58, v58
    v_exp_f32 v59, v59
    v_cvt_pk_bf16_f32 v130, v56, v57
    v_cvt_pk_bf16_f32 v131, v58, v59
    v_mfma_f32_32x32x16_bf16 v[44:59], v[108:111], v[16:19], 0
    s_waitcnt lgkmcnt(2)
    buffer_load_dwordx4 v2, s[24:27], s34 offen offset:3072 sc1 lds
    s_lshl_b32 s67, s65, 12
    s_add_u32 s67, s67, s64
    buffer_load_dwordx4 v[172:175], v137, s[24:27], s67 offen offset:0 sc1
    v_exp_f32 v60, v60
    v_exp_f32 v61, v61
    v_exp_f32 v62, v62
    v_exp_f32 v63, v63
    v_cvt_pk_bf16_f32 v124, v60, v61
    v_cvt_pk_bf16_f32 v125, v62, v63
    v_mfma_f32_32x32x16_bf16 v[44:59], v[112:115], v[20:23], v[44:59]
    s_waitcnt lgkmcnt(0)
    buffer_load_dwordx4 v[176:179], v137, s[24:27], s67 offen offset:1024 sc1
    s_add_u32 s65, s65, 1
    s_cmp_eq_u32 s65, 7
    s_cselect_b32 s65, 0, s65
    v_exp_f32 v64, v64
    v_exp_f32 v65, v65
    v_exp_f32 v66, v66
    v_exp_f32 v67, v67
    v_cvt_pk_bf16_f32 v126, v64, v65
    v_cvt_pk_bf16_f32 v127, v66, v67
    v_mfma_f32_32x32x16_bf16 v[76:91], v[120:123], v[128:131], v[76:91]
    buffer_load_dwordx4 v[180:183], v137, s[24:27], s67 offen offset:2048 sc1
    v_exp_f32 v68, v68
    v_exp_f32 v69, v69
    v_exp_f32 v70, v70
    v_exp_f32 v71, v71
    v_cvt_pk_bf16_f32 v128, v68, v69
    v_cvt_pk_bf16_f32 v129, v70, v71
    v_mfma_f32_32x32x16_bf16 v[92:107], v[116:119], v[124:127], v[92:107]
    ds_read_b64_tr_b16 v[116:117], v35 offset:0
    buffer_load_dwordx4 v[184:187], v137, s[24:27], s67 offen offset:3072 sc1
    v_exp_f32 v72, v72
    v_exp_f32 v73, v73
    v_exp_f32 v74, v74
    v_exp_f32 v75, v75
    v_cvt_pk_bf16_f32 v130, v72, v73
    v_cvt_pk_bf16_f32 v131, v74, v75
    v_mfma_f32_32x32x16_bf16 v[60:75], v[108:111], v[24:27], 0
    ds_read_b64_tr_b16 v[118:119], v35 offset:256
    s_lshl_b32 s67, s65, 12
    s_add_u32 s67, s67, s64
    buffer_load_dwordx4 v[188:191], v137, s[24:27], s67 offen offset:0 sc1
    v_exp_f32 v44, v44
    v_exp_f32 v45, v45
    v_exp_f32 v46, v46
    v_exp_f32 v47, v47
    v_cvt_pk_bf16_f32 v124, v44, v45
    v_cvt_pk_bf16_f32 v125, v46, v47
    v_mfma_f32_32x32x16_bf16 v[60:75], v[112:115], v[28:31], v[60:75]
    ds_read_b128 v[108:111], v33 offset:4096
    buffer_load_dwordx4 v[192:195], v137, s[24:27], s67 offen offset:1024 sc1
    s_add_u32 s65, s65, 1
    s_cmp_eq_u32 s65, 7
    s_cselect_b32 s65, 0, s65
    v_exp_f32 v48, v48
    v_exp_f32 v49, v49
    v_exp_f32 v50, v50
    v_exp_f32 v51, v51
    v_cvt_pk_bf16_f32 v126, v48, v49
    v_cvt_pk_bf16_f32 v127, v50, v51
    v_mfma_f32_32x32x16_bf16 v[92:107], v[120:123], v[128:131], v[92:107]
    ds_read_b128 v[112:115], v33 offset:5120
    ds_read_b64_tr_b16 v[120:121], v35 offset:512
    buffer_load_dwordx4 v[196:199], v137, s[24:27], s67 offen offset:2048 sc1
    v_exp_f32 v52, v52
    v_exp_f32 v53, v53
    v_exp_f32 v54, v54
    v_exp_f32 v55, v55
    v_cvt_pk_bf16_f32 v128, v52, v53
    v_cvt_pk_bf16_f32 v129, v54, v55
    s_waitcnt lgkmcnt(2)
    v_mfma_f32_32x32x16_bf16 v[76:91], v[116:119], v[124:127], v[76:91]
    ds_read_b64_tr_b16 v[122:123], v35 offset:768
    buffer_load_dwordx4 v[200:203], v137, s[24:27], s67 offen offset:3072 sc1
    v_exp_f32 v56, v56
    v_exp_f32 v57, v57
    v_exp_f32 v58, v58
    v_exp_f32 v59, v59
    v_cvt_pk_bf16_f32 v130, v56, v57
    v_cvt_pk_bf16_f32 v131, v58, v59
    v_mfma_f32_32x32x16_bf16 v[44:59], v[108:111], v[16:19], 0
    s_waitcnt lgkmcnt(2)
    s_lshl_b32 s67, s65, 12
    s_add_u32 s67, s67, s64
    buffer_load_dwordx4 v[204:207], v137, s[24:27], s67 offen offset:0 sc1
    v_exp_f32 v60, v60
    v_exp_f32 v61, v61
    v_exp_f32 v62, v62
    v_exp_f32 v63, v63
    v_cvt_pk_bf16_f32 v124, v60, v61
    v_cvt_pk_bf16_f32 v125, v62, v63
    v_mfma_f32_32x32x16_bf16 v[44:59], v[112:115], v[20:23], v[44:59]
    s_waitcnt lgkmcnt(0)
    buffer_load_dwordx4 v[208:211], v137, s[24:27], s67 offen offset:1024 sc1
    s_add_u32 s65, s65, 1
    s_cmp_eq_u32 s65, 7
    s_cselect_b32 s65, 0, s65
    v_exp_f32 v64, v64
    v_exp_f32 v65, v65
    v_exp_f32 v66, v66
    v_exp_f32 v67, v67
    v_cvt_pk_bf16_f32 v126, v64, v65
    v_cvt_pk_bf16_f32 v127, v66, v67
    v_mfma_f32_32x32x16_bf16 v[76:91], v[120:123], v[128:131], v[76:91]
    buffer_load_dwordx4 v[212:215], v137, s[24:27], s67 offen offset:2048 sc1
    v_exp_f32 v68, v68
    v_exp_f32 v69, v69
    v_exp_f32 v70, v70
    v_exp_f32 v71, v71
    v_cvt_pk_bf16_f32 v128, v68, v69
    v_cvt_pk_bf16_f32 v129, v70, v71
    v_mfma_f32_32x32x16_bf16 v[92:107], v[116:119], v[124:127], v[92:107]
    ds_read_b64_tr_b16 v[116:117], v35 offset:4096
    buffer_load_dwordx4 v[216:219], v137, s[24:27], s67 offen offset:3072 sc1
    v_exp_f32 v72, v72
    v_exp_f32 v73, v73
    v_exp_f32 v74, v74
    v_exp_f32 v75, v75
    v_cvt_pk_bf16_f32 v130, v72, v73
    v_cvt_pk_bf16_f32 v131, v74, v75
    v_mfma_f32_32x32x16_bf16 v[60:75], v[108:111], v[24:27], 0
    ds_read_b64_tr_b16 v[118:119], v35 offset:4352
    s_waitcnt vmcnt(28)
    s_barrier
    s_add_u32 m0, s54, 16384
    s_add_u32 s34, s66, 4096
    buffer_load_dwordx4 v2, s[24:27], s34 offen offset:0 sc1 lds
    v_exp_f32 v44, v44
    v_exp_f32 v45, v45
    v_exp_f32 v46, v46
    v_exp_f32 v47, v47
    v_cvt_pk_bf16_f32 v124, v44, v45
    v_cvt_pk_bf16_f32 v125, v46, v47
    v_mfma_f32_32x32x16_bf16 v[60:75], v[112:115], v[28:31], v[60:75]
    ds_read_b128 v[108:111], v33 offset:32768
    buffer_load_dwordx4 v2, s[24:27], s34 offen offset:1024 sc1 lds
    v_exp_f32 v48, v48
    v_exp_f32 v49, v49
    v_exp_f32 v50, v50
    v_exp_f32 v51, v51
    v_cvt_pk_bf16_f32 v126, v48, v49
    v_cvt_pk_bf16_f32 v127, v50, v51
    v_mfma_f32_32x32x16_bf16 v[92:107], v[120:123], v[128:131], v[92:107]
    ds_read_b128 v[112:115], v33 offset:33792
    ds_read_b64_tr_b16 v[120:121], v35 offset:4608
    buffer_load_dwordx4 v2, s[24:27], s34 offen offset:2048 sc1 lds
    v_exp_f32 v52, v52
    v_exp_f32 v53, v53
    v_exp_f32 v54, v54
    v_exp_f32 v55, v55
    v_cvt_pk_bf16_f32 v128, v52, v53
    v_cvt_pk_bf16_f32 v129, v54, v55
    s_waitcnt lgkmcnt(2)
    v_mfma_f32_32x32x16_bf16 v[76:91], v[116:119], v[124:127], v[76:91]
    ds_read_b64_tr_b16 v[122:123], v35 offset:4864
    buffer_load_dwordx4 v2, s[24:27], s34 offen offset:3072 sc1 lds
    v_exp_f32 v56, v56
    v_exp_f32 v57, v57
    v_exp_f32 v58, v58
    v_exp_f32 v59, v59
    v_cvt_pk_bf16_f32 v130, v56, v57
    v_cvt_pk_bf16_f32 v131, v58, v59
    v_mfma_f32_32x32x16_bf16 v[44:59], v[108:111], v[16:19], 0
    s_waitcnt lgkmcnt(2)
    s_add_u32 m0, s54, 32768
    s_add_u32 s34, s66, 36864
    buffer_load_dwordx4 v2, s[24:27], s34 offen offset:0 sc1 lds
    v_exp_f32 v60, v60
    v_exp_f32 v61, v61
    v_exp_f32 v62, v62
    v_exp_f32 v63, v63
    v_cvt_pk_bf16_f32 v124, v60, v61
    v_cvt_pk_bf16_f32 v125, v62, v63
    v_mfma_f32_32x32x16_bf16 v[44:59], v[112:115], v[20:23], v[44:59]
    s_waitcnt lgkmcnt(0)
    buffer_load_dwordx4 v2, s[24:27], s34 offen offset:1024 sc1 lds
    v_exp_f32 v64, v64
    v_exp_f32 v65, v65
    v_exp_f32 v66, v66
    v_exp_f32 v67, v67
    v_cvt_pk_bf16_f32 v126, v64, v65
    v_cvt_pk_bf16_f32 v127, v66, v67
    v_mfma_f32_32x32x16_bf16 v[76:91], v[120:123], v[128:131], v[76:91]
    buffer_load_dwordx4 v2, s[24:27], s34 offen offset:2048 sc1 lds
    v_exp_f32 v68, v68
    v_exp_f32 v69, v69
    v_exp_f32 v70, v70
    v_exp_f32 v71, v71
    v_cvt_pk_bf16_f32 v128, v68, v69
    v_cvt_pk_bf16_f32 v129, v70, v71
    v_mfma_f32_32x32x16_bf16 v[92:107], v[116:119], v[124:127], v[92:107]
    ds_read_b64_tr_b16 v[116:117], v35 offset:32768
    buffer_load_dwordx4 v2, s[24:27], s34 offen offset:3072 sc1 lds
    v_exp_f32 v72, v72
    v_exp_f32 v73, v73
    v_exp_f32 v74, v74
    v_exp_f32 v75, v75
    v_cvt_pk_bf16_f32 v130, v72, v73
    v_cvt_pk_bf16_f32 v131, v74, v75
    v_mfma_f32_32x32x16_bf16 v[60:75], v[108:111], v[24:27], 0
    ds_read_b64_tr_b16 v[118:119], v35 offset:33024
    s_lshl_b32 s67, s65, 12
    s_add_u32 s67, s67, s64
    buffer_load_dwordx4 v[220:223], v137, s[24:27], s67 offen offset:0 sc1
    v_exp_f32 v44, v44
    v_exp_f32 v45, v45
    v_exp_f32 v46, v46
    v_exp_f32 v47, v47
    v_cvt_pk_bf16_f32 v124, v44, v45
    v_cvt_pk_bf16_f32 v125, v46, v47
    v_mfma_f32_32x32x16_bf16 v[60:75], v[112:115], v[28:31], v[60:75]
    ds_read_b128 v[108:111], v33 offset:36864
    buffer_load_dwordx4 v[224:227], v137, s[24:27], s67 offen offset:1024 sc1
    s_add_u32 s65, s65, 1
    s_cmp_eq_u32 s65, 7
    s_cselect_b32 s65, 0, s65
    v_exp_f32 v48, v48
    v_exp_f32 v49, v49
    v_exp_f32 v50, v50
    v_exp_f32 v51, v51
    v_cvt_pk_bf16_f32 v126, v48, v49
    v_cvt_pk_bf16_f32 v127, v50, v51
    v_mfma_f32_32x32x16_bf16 v[92:107], v[120:123], v[128:131], v[92:107]
    ds_read_b128 v[112:115], v33 offset:37888
    ds_read_b64_tr_b16 v[120:121], v35 offset:33280
    buffer_load_dwordx4 v[228:231], v137, s[24:27], s67 offen offset:2048 sc1
    v_exp_f32 v52, v52
    v_exp_f32 v53, v53
    v_exp_f32 v54, v54
    v_exp_f32 v55, v55
    v_cvt_pk_bf16_f32 v128, v52, v53
    v_cvt_pk_bf16_f32 v129, v54, v55
    s_waitcnt lgkmcnt(2)
    v_mfma_f32_32x32x16_bf16 v[76:91], v[116:119], v[124:127], v[76:91]
    ds_read_b64_tr_b16 v[122:123], v35 offset:33536
    buffer_load_dwordx4 v[232:235], v137, s[24:27], s67 offen offset:3072 sc1
    v_exp_f32 v56, v56
    v_exp_f32 v57, v57
    v_exp_f32 v58, v58
    v_exp_f32 v59, v59
    v_cvt_pk_bf16_f32 v130, v56, v57
    v_cvt_pk_bf16_f32 v131, v58, v59
    v_mfma_f32_32x32x16_bf16 v[44:59], v[108:111], v[16:19], 0
    s_waitcnt lgkmcnt(2)
    s_lshl_b32 s67, s65, 12
    s_add_u32 s67, s67, s64
    buffer_load_dwordx4 v[236:239], v137, s[24:27], s67 offen offset:0 sc1
    v_exp_f32 v60, v60
    v_exp_f32 v61, v61
    v_exp_f32 v62, v62
    v_exp_f32 v63, v63
    v_cvt_pk_bf16_f32 v124, v60, v61
    v_cvt_pk_bf16_f32 v125, v62, v63
    v_mfma_f32_32x32x16_bf16 v[44:59], v[112:115], v[20:23], v[44:59]
    s_waitcnt lgkmcnt(0)
    buffer_load_dwordx4 v[240:243], v137, s[24:27], s67 offen offset:1024 sc1
    s_add_u32 s65, s65, 1
    s_cmp_eq_u32 s65, 7
    s_cselect_b32 s65, 0, s65
    v_exp_f32 v64, v64
    v_exp_f32 v65, v65
    v_exp_f32 v66, v66
    v_exp_f32 v67, v67
    v_cvt_pk_bf16_f32 v126, v64, v65
    v_cvt_pk_bf16_f32 v127, v66, v67
    v_mfma_f32_32x32x16_bf16 v[76:91], v[120:123], v[128:131], v[76:91]
    buffer_load_dwordx4 v[244:247], v137, s[24:27], s67 offen offset:2048 sc1
    v_exp_f32 v68, v68
    v_exp_f32 v69, v69
    v_exp_f32 v70, v70
    v_exp_f32 v71, v71
    v_cvt_pk_bf16_f32 v128, v68, v69
    v_cvt_pk_bf16_f32 v129, v70, v71
    v_mfma_f32_32x32x16_bf16 v[92:107], v[116:119], v[124:127], v[92:107]
    ds_read_b64_tr_b16 v[116:117], v35 offset:36864
    buffer_load_dwordx4 v[248:251], v137, s[24:27], s67 offen offset:3072 sc1
    v_exp_f32 v72, v72
    v_exp_f32 v73, v73
    v_exp_f32 v74, v74
    v_exp_f32 v75, v75
    v_cvt_pk_bf16_f32 v130, v72, v73
    v_cvt_pk_bf16_f32 v131, v74, v75
    v_mfma_f32_32x32x16_bf16 v[60:75], v[108:111], v[24:27], 0
    ds_read_b64_tr_b16 v[118:119], v35 offset:37120
    s_barrier
    v_exp_f32 v44, v44
    v_exp_f32 v45, v45
    v_exp_f32 v46, v46
    v_exp_f32 v47, v47
    v_cvt_pk_bf16_f32 v124, v44, v45
    v_cvt_pk_bf16_f32 v125, v46, v47
    v_mfma_f32_32x32x16_bf16 v[60:75], v[112:115], v[28:31], v[60:75]
    v_exp_f32 v48, v48
    v_exp_f32 v49, v49
    v_exp_f32 v50, v50
    v_exp_f32 v51, v51
    v_cvt_pk_bf16_f32 v126, v48, v49
    v_cvt_pk_bf16_f32 v127, v50, v51
    v_mfma_f32_32x32x16_bf16 v[92:107], v[120:123], v[128:131], v[92:107]
    ds_read_b64_tr_b16 v[120:121], v35 offset:37376
    v_exp_f32 v52, v52
    v_exp_f32 v53, v53
    v_exp_f32 v54, v54
    v_exp_f32 v55, v55
    v_cvt_pk_bf16_f32 v128, v52, v53
    v_cvt_pk_bf16_f32 v129, v54, v55
    s_waitcnt lgkmcnt(1)
    v_mfma_f32_32x32x16_bf16 v[76:91], v[116:119], v[124:127], v[76:91]
    ds_read_b64_tr_b16 v[122:123], v35 offset:37632
    v_exp_f32 v56, v56
    v_exp_f32 v57, v57
    v_exp_f32 v58, v58
    v_exp_f32 v59, v59
    v_cvt_pk_bf16_f32 v130, v56, v57
    v_cvt_pk_bf16_f32 v131, v58, v59
    v_exp_f32 v60, v60
    v_exp_f32 v61, v61
    v_exp_f32 v62, v62
    v_exp_f32 v63, v63
    v_cvt_pk_bf16_f32 v124, v60, v61
    v_cvt_pk_bf16_f32 v125, v62, v63
    s_waitcnt lgkmcnt(0)
    v_exp_f32 v64, v64
    v_exp_f32 v65, v65
    v_exp_f32 v66, v66
    v_exp_f32 v67, v67
    v_cvt_pk_bf16_f32 v126, v64, v65
    v_cvt_pk_bf16_f32 v127, v66, v67
    v_mfma_f32_32x32x16_bf16 v[76:91], v[120:123], v[128:131], v[76:91]
    v_exp_f32 v68, v68
    v_exp_f32 v69, v69
    v_exp_f32 v70, v70
    v_exp_f32 v71, v71
    v_cvt_pk_bf16_f32 v128, v68, v69
    v_cvt_pk_bf16_f32 v129, v70, v71
    v_mfma_f32_32x32x16_bf16 v[92:107], v[116:119], v[124:127], v[92:107]
    v_exp_f32 v72, v72
    v_exp_f32 v73, v73
    v_exp_f32 v74, v74
    v_exp_f32 v75, v75
    s_branch MAINE_sequential_preLN__softmax_full_mha__glu_gated_reglu__prompt_kernel_24
MAINL_sequential_preLN__softmax_full_mha__glu_gated_reglu__prompt_kernel_23:
    ds_read_b64_tr_b16 v[118:119], v34 offset:256
    ds_read_b64_tr_b16 v[120:121], v34 offset:512
    ds_read_b64_tr_b16 v[122:123], v34 offset:768
    s_nop 5
    v_mfma_f32_32x32x16_bf16 v[60:75], v[108:111], v[24:27], 0
    ds_read_b128 v[144:147], v32 offset:4096
    v_exp_f32 v44, v44
    v_exp_f32 v45, v45
    v_exp_f32 v46, v46
    v_exp_f32 v47, v47
    v_cvt_pk_bf16_f32 v124, v44, v45
    v_cvt_pk_bf16_f32 v125, v46, v47
    v_mfma_f32_32x32x16_bf16 v[60:75], v[112:115], v[28:31], v[60:75]
    ds_read_b128 v[148:151], v32 offset:5120
    v_exp_f32 v48, v48
    v_exp_f32 v49, v49
    v_exp_f32 v50, v50
    v_exp_f32 v51, v51
    v_cvt_pk_bf16_f32 v126, v48, v49
    v_cvt_pk_bf16_f32 v127, v50, v51
    s_waitcnt lgkmcnt(2)
    v_exp_f32 v52, v52
    v_exp_f32 v53, v53
    v_exp_f32 v54, v54
    v_exp_f32 v55, v55
    v_cvt_pk_bf16_f32 v128, v52, v53
    v_cvt_pk_bf16_f32 v129, v54, v55
    v_mfma_f32_32x32x16_bf16 v[76:91], v[116:119], v[124:127], 0
    s_waitcnt lgkmcnt(0)
    v_exp_f32 v56, v56
    v_exp_f32 v57, v57
    v_exp_f32 v58, v58
    v_exp_f32 v59, v59
    v_cvt_pk_bf16_f32 v130, v56, v57
    v_cvt_pk_bf16_f32 v131, v58, v59
    v_mfma_f32_32x32x16_bf16 v[44:59], v[144:147], v[16:19], 0
    ds_read_b64_tr_b16 v[152:153], v34 offset:4096
    v_exp_f32 v60, v60
    v_exp_f32 v61, v61
    v_exp_f32 v62, v62
    v_exp_f32 v63, v63
    v_cvt_pk_bf16_f32 v124, v60, v61
    v_cvt_pk_bf16_f32 v125, v62, v63
    v_mfma_f32_32x32x16_bf16 v[44:59], v[148:151], v[20:23], v[44:59]
    ds_read_b64_tr_b16 v[154:155], v34 offset:4352
    v_exp_f32 v64, v64
    v_exp_f32 v65, v65
    v_exp_f32 v66, v66
    v_exp_f32 v67, v67
    v_cvt_pk_bf16_f32 v126, v64, v65
    v_cvt_pk_bf16_f32 v127, v66, v67
    v_mfma_f32_32x32x16_bf16 v[76:91], v[120:123], v[128:131], v[76:91]
    ds_read_b64_tr_b16 v[156:157], v34 offset:4608
    v_exp_f32 v68, v68
    v_exp_f32 v69, v69
    v_exp_f32 v70, v70
    v_exp_f32 v71, v71
    v_cvt_pk_bf16_f32 v128, v68, v69
    v_cvt_pk_bf16_f32 v129, v70, v71
    v_mfma_f32_32x32x16_bf16 v[92:107], v[116:119], v[124:127], 0
    ds_read_b64_tr_b16 v[158:159], v34 offset:4864
    v_exp_f32 v72, v72
    v_exp_f32 v73, v73
    v_exp_f32 v74, v74
    v_exp_f32 v75, v75
    v_cvt_pk_bf16_f32 v130, v72, v73
    v_cvt_pk_bf16_f32 v131, v74, v75
    v_mfma_f32_32x32x16_bf16 v[60:75], v[144:147], v[24:27], 0
    s_waitcnt vmcnt(0)
    s_barrier
    ds_read_b128 v[108:111], v32 offset:32768
    v_exp_f32 v44, v44
    v_exp_f32 v45, v45
    v_exp_f32 v46, v46
    v_exp_f32 v47, v47
    v_cvt_pk_bf16_f32 v124, v44, v45
    v_cvt_pk_bf16_f32 v125, v46, v47
    v_mfma_f32_32x32x16_bf16 v[60:75], v[148:151], v[28:31], v[60:75]
    ds_read_b128 v[112:115], v32 offset:33792
    v_exp_f32 v48, v48
    v_exp_f32 v49, v49
    v_exp_f32 v50, v50
    v_exp_f32 v51, v51
    v_cvt_pk_bf16_f32 v126, v48, v49
    v_cvt_pk_bf16_f32 v127, v50, v51
    v_mfma_f32_32x32x16_bf16 v[92:107], v[120:123], v[128:131], v[92:107]
    s_waitcnt lgkmcnt(2)
    v_exp_f32 v52, v52
    v_exp_f32 v53, v53
    v_exp_f32 v54, v54
    v_exp_f32 v55, v55
    v_cvt_pk_bf16_f32 v128, v52, v53
    v_cvt_pk_bf16_f32 v129, v54, v55
    v_mfma_f32_32x32x16_bf16 v[76:91], v[152:155], v[124:127], v[76:91]
    s_waitcnt lgkmcnt(0)
    v_exp_f32 v56, v56
    v_exp_f32 v57, v57
    v_exp_f32 v58, v58
    v_exp_f32 v59, v59
    v_cvt_pk_bf16_f32 v130, v56, v57
    v_cvt_pk_bf16_f32 v131, v58, v59
    v_mfma_f32_32x32x16_bf16 v[44:59], v[108:111], v[16:19], 0
    ds_read_b64_tr_b16 v[116:117], v34 offset:32768
    v_exp_f32 v60, v60
    v_exp_f32 v61, v61
    v_exp_f32 v62, v62
    v_exp_f32 v63, v63
    v_cvt_pk_bf16_f32 v124, v60, v61
    v_cvt_pk_bf16_f32 v125, v62, v63
    v_mfma_f32_32x32x16_bf16 v[44:59], v[112:115], v[20:23], v[44:59]
    ds_read_b64_tr_b16 v[118:119], v34 offset:33024
    v_exp_f32 v64, v64
    v_exp_f32 v65, v65
    v_exp_f32 v66, v66
    v_exp_f32 v67, v67
    v_cvt_pk_bf16_f32 v126, v64, v65
    v_cvt_pk_bf16_f32 v127, v66, v67
    v_mfma_f32_32x32x16_bf16 v[76:91], v[156:159], v[128:131], v[76:91]
    ds_read_b64_tr_b16 v[120:121], v34 offset:33280
    v_exp_f32 v68, v68
    v_exp_f32 v69, v69
    v_exp_f32 v70, v70
    v_exp_f32 v71, v71
    v_cvt_pk_bf16_f32 v128, v68, v69
    v_cvt_pk_bf16_f32 v129, v70, v71
    v_mfma_f32_32x32x16_bf16 v[92:107], v[152:155], v[124:127], v[92:107]
    ds_read_b64_tr_b16 v[122:123], v34 offset:33536
    v_exp_f32 v72, v72
    v_exp_f32 v73, v73
    v_exp_f32 v74, v74
    v_exp_f32 v75, v75
    v_cvt_pk_bf16_f32 v130, v72, v73
    v_cvt_pk_bf16_f32 v131, v74, v75
    v_mfma_f32_32x32x16_bf16 v[60:75], v[108:111], v[24:27], 0
    ds_read_b128 v[144:147], v32 offset:36864
    v_exp_f32 v44, v44
    v_exp_f32 v45, v45
    v_exp_f32 v46, v46
    v_exp_f32 v47, v47
    v_cvt_pk_bf16_f32 v124, v44, v45
    v_cvt_pk_bf16_f32 v125, v46, v47
    v_mfma_f32_32x32x16_bf16 v[60:75], v[112:115], v[28:31], v[60:75]
    ds_read_b128 v[148:151], v32 offset:37888
    v_exp_f32 v48, v48
    v_exp_f32 v49, v49
    v_exp_f32 v50, v50
    v_exp_f32 v51, v51
    v_cvt_pk_bf16_f32 v126, v48, v49
    v_cvt_pk_bf16_f32 v127, v50, v51
    v_mfma_f32_32x32x16_bf16 v[92:107], v[156:159], v[128:131], v[92:107]
    s_waitcnt lgkmcnt(2)
    v_exp_f32 v52, v52
    v_exp_f32 v53, v53
    v_exp_f32 v54, v54
    v_exp_f32 v55, v55
    v_cvt_pk_bf16_f32 v128, v52, v53
    v_cvt_pk_bf16_f32 v129, v54, v55
    v_mfma_f32_32x32x16_bf16 v[76:91], v[116:119], v[124:127], v[76:91]
    s_waitcnt lgkmcnt(0)
    v_exp_f32 v56, v56
    v_exp_f32 v57, v57
    v_exp_f32 v58, v58
    v_exp_f32 v59, v59
    v_cvt_pk_bf16_f32 v130, v56, v57
    v_cvt_pk_bf16_f32 v131, v58, v59
    v_mfma_f32_32x32x16_bf16 v[44:59], v[144:147], v[16:19], 0
    ds_read_b64_tr_b16 v[152:153], v34 offset:36864
    v_exp_f32 v60, v60
    v_exp_f32 v61, v61
    v_exp_f32 v62, v62
    v_exp_f32 v63, v63
    v_cvt_pk_bf16_f32 v124, v60, v61
    v_cvt_pk_bf16_f32 v125, v62, v63
    v_mfma_f32_32x32x16_bf16 v[44:59], v[148:151], v[20:23], v[44:59]
    ds_read_b64_tr_b16 v[154:155], v34 offset:37120
    v_exp_f32 v64, v64
    v_exp_f32 v65, v65
    v_exp_f32 v66, v66
    v_exp_f32 v67, v67
    v_cvt_pk_bf16_f32 v126, v64, v65
    v_cvt_pk_bf16_f32 v127, v66, v67
    v_mfma_f32_32x32x16_bf16 v[76:91], v[120:123], v[128:131], v[76:91]
    ds_read_b64_tr_b16 v[156:157], v34 offset:37376
    v_exp_f32 v68, v68
    v_exp_f32 v69, v69
    v_exp_f32 v70, v70
    v_exp_f32 v71, v71
    v_cvt_pk_bf16_f32 v128, v68, v69
    v_cvt_pk_bf16_f32 v129, v70, v71
    v_mfma_f32_32x32x16_bf16 v[92:107], v[116:119], v[124:127], v[92:107]
    ds_read_b64_tr_b16 v[158:159], v34 offset:37632
    v_exp_f32 v72, v72
    v_exp_f32 v73, v73
    v_exp_f32 v74, v74
    v_exp_f32 v75, v75
    v_cvt_pk_bf16_f32 v130, v72, v73
    v_cvt_pk_bf16_f32 v131, v74, v75
    v_mfma_f32_32x32x16_bf16 v[60:75], v[144:147], v[24:27], 0
    s_barrier
    ds_read_b128 v[108:111], v33 offset:0
    v_exp_f32 v44, v44
    v_exp_f32 v45, v45
    v_exp_f32 v46, v46
    v_exp_f32 v47, v47
    v_cvt_pk_bf16_f32 v124, v44, v45
    v_cvt_pk_bf16_f32 v125, v46, v47
    v_mfma_f32_32x32x16_bf16 v[60:75], v[148:151], v[28:31], v[60:75]
    ds_read_b128 v[112:115], v33 offset:1024
    v_exp_f32 v48, v48
    v_exp_f32 v49, v49
    v_exp_f32 v50, v50
    v_exp_f32 v51, v51
    v_cvt_pk_bf16_f32 v126, v48, v49
    v_cvt_pk_bf16_f32 v127, v50, v51
    v_mfma_f32_32x32x16_bf16 v[92:107], v[120:123], v[128:131], v[92:107]
    s_waitcnt lgkmcnt(2)
    v_exp_f32 v52, v52
    v_exp_f32 v53, v53
    v_exp_f32 v54, v54
    v_exp_f32 v55, v55
    v_cvt_pk_bf16_f32 v128, v52, v53
    v_cvt_pk_bf16_f32 v129, v54, v55
    v_mfma_f32_32x32x16_bf16 v[76:91], v[152:155], v[124:127], v[76:91]
    s_waitcnt lgkmcnt(0)
    v_exp_f32 v56, v56
    v_exp_f32 v57, v57
    v_exp_f32 v58, v58
    v_exp_f32 v59, v59
    v_cvt_pk_bf16_f32 v130, v56, v57
    v_cvt_pk_bf16_f32 v131, v58, v59
    v_mfma_f32_32x32x16_bf16 v[44:59], v[108:111], v[16:19], 0
    ds_read_b64_tr_b16 v[116:117], v35 offset:0
    v_exp_f32 v60, v60
    v_exp_f32 v61, v61
    v_exp_f32 v62, v62
    v_exp_f32 v63, v63
    v_cvt_pk_bf16_f32 v124, v60, v61
    v_cvt_pk_bf16_f32 v125, v62, v63
    v_mfma_f32_32x32x16_bf16 v[44:59], v[112:115], v[20:23], v[44:59]
    ds_read_b64_tr_b16 v[118:119], v35 offset:256
    v_exp_f32 v64, v64
    v_exp_f32 v65, v65
    v_exp_f32 v66, v66
    v_exp_f32 v67, v67
    v_cvt_pk_bf16_f32 v126, v64, v65
    v_cvt_pk_bf16_f32 v127, v66, v67
    v_mfma_f32_32x32x16_bf16 v[76:91], v[156:159], v[128:131], v[76:91]
    ds_read_b64_tr_b16 v[120:121], v35 offset:512
    v_exp_f32 v68, v68
    v_exp_f32 v69, v69
    v_exp_f32 v70, v70
    v_exp_f32 v71, v71
    v_cvt_pk_bf16_f32 v128, v68, v69
    v_cvt_pk_bf16_f32 v129, v70, v71
    v_mfma_f32_32x32x16_bf16 v[92:107], v[152:155], v[124:127], v[92:107]
    ds_read_b64_tr_b16 v[122:123], v35 offset:768
    v_exp_f32 v72, v72
    v_exp_f32 v73, v73
    v_exp_f32 v74, v74
    v_exp_f32 v75, v75
    v_cvt_pk_bf16_f32 v130, v72, v73
    v_cvt_pk_bf16_f32 v131, v74, v75
    v_mfma_f32_32x32x16_bf16 v[60:75], v[108:111], v[24:27], 0
    ds_read_b128 v[144:147], v33 offset:4096
    v_exp_f32 v44, v44
    v_exp_f32 v45, v45
    v_exp_f32 v46, v46
    v_exp_f32 v47, v47
    v_cvt_pk_bf16_f32 v124, v44, v45
    v_cvt_pk_bf16_f32 v125, v46, v47
    v_mfma_f32_32x32x16_bf16 v[60:75], v[112:115], v[28:31], v[60:75]
    ds_read_b128 v[148:151], v33 offset:5120
    v_exp_f32 v48, v48
    v_exp_f32 v49, v49
    v_exp_f32 v50, v50
    v_exp_f32 v51, v51
    v_cvt_pk_bf16_f32 v126, v48, v49
    v_cvt_pk_bf16_f32 v127, v50, v51
    v_mfma_f32_32x32x16_bf16 v[92:107], v[156:159], v[128:131], v[92:107]
    s_waitcnt lgkmcnt(2)
    v_exp_f32 v52, v52
    v_exp_f32 v53, v53
    v_exp_f32 v54, v54
    v_exp_f32 v55, v55
    v_cvt_pk_bf16_f32 v128, v52, v53
    v_cvt_pk_bf16_f32 v129, v54, v55
    v_mfma_f32_32x32x16_bf16 v[76:91], v[116:119], v[124:127], v[76:91]
    s_waitcnt lgkmcnt(0)
    v_exp_f32 v56, v56
    v_exp_f32 v57, v57
    v_exp_f32 v58, v58
    v_exp_f32 v59, v59
    v_cvt_pk_bf16_f32 v130, v56, v57
    v_cvt_pk_bf16_f32 v131, v58, v59
    v_mfma_f32_32x32x16_bf16 v[44:59], v[144:147], v[16:19], 0
    ds_read_b64_tr_b16 v[152:153], v35 offset:4096
    v_exp_f32 v60, v60
    v_exp_f32 v61, v61
    v_exp_f32 v62, v62
    v_exp_f32 v63, v63
    v_cvt_pk_bf16_f32 v124, v60, v61
    v_cvt_pk_bf16_f32 v125, v62, v63
    v_mfma_f32_32x32x16_bf16 v[44:59], v[148:151], v[20:23], v[44:59]
    ds_read_b64_tr_b16 v[154:155], v35 offset:4352
    v_exp_f32 v64, v64
    v_exp_f32 v65, v65
    v_exp_f32 v66, v66
    v_exp_f32 v67, v67
    v_cvt_pk_bf16_f32 v126, v64, v65
    v_cvt_pk_bf16_f32 v127, v66, v67
    v_mfma_f32_32x32x16_bf16 v[76:91], v[120:123], v[128:131], v[76:91]
    ds_read_b64_tr_b16 v[156:157], v35 offset:4608
    v_exp_f32 v68, v68
    v_exp_f32 v69, v69
    v_exp_f32 v70, v70
    v_exp_f32 v71, v71
    v_cvt_pk_bf16_f32 v128, v68, v69
    v_cvt_pk_bf16_f32 v129, v70, v71
    v_mfma_f32_32x32x16_bf16 v[92:107], v[116:119], v[124:127], v[92:107]
    ds_read_b64_tr_b16 v[158:159], v35 offset:4864
    v_exp_f32 v72, v72
    v_exp_f32 v73, v73
    v_exp_f32 v74, v74
    v_exp_f32 v75, v75
    v_cvt_pk_bf16_f32 v130, v72, v73
    v_cvt_pk_bf16_f32 v131, v74, v75
    v_mfma_f32_32x32x16_bf16 v[60:75], v[144:147], v[24:27], 0
    s_barrier
    ds_read_b128 v[108:111], v33 offset:32768
    v_exp_f32 v44, v44
    v_exp_f32 v45, v45
    v_exp_f32 v46, v46
    v_exp_f32 v47, v47
    v_cvt_pk_bf16_f32 v124, v44, v45
    v_cvt_pk_bf16_f32 v125, v46, v47
    v_mfma_f32_32x32x16_bf16 v[60:75], v[148:151], v[28:31], v[60:75]
    ds_read_b128 v[112:115], v33 offset:33792
    v_exp_f32 v48, v48
    v_exp_f32 v49, v49
    v_exp_f32 v50, v50
    v_exp_f32 v51, v51
    v_cvt_pk_bf16_f32 v126, v48, v49
    v_cvt_pk_bf16_f32 v127, v50, v51
    v_mfma_f32_32x32x16_bf16 v[92:107], v[120:123], v[128:131], v[92:107]
    s_waitcnt lgkmcnt(2)
    v_exp_f32 v52, v52
    v_exp_f32 v53, v53
    v_exp_f32 v54, v54
    v_exp_f32 v55, v55
    v_cvt_pk_bf16_f32 v128, v52, v53
    v_cvt_pk_bf16_f32 v129, v54, v55
    v_mfma_f32_32x32x16_bf16 v[76:91], v[152:155], v[124:127], v[76:91]
    s_waitcnt lgkmcnt(0)
    v_exp_f32 v56, v56
    v_exp_f32 v57, v57
    v_exp_f32 v58, v58
    v_exp_f32 v59, v59
    v_cvt_pk_bf16_f32 v130, v56, v57
    v_cvt_pk_bf16_f32 v131, v58, v59
    v_mfma_f32_32x32x16_bf16 v[44:59], v[108:111], v[16:19], 0
    ds_read_b64_tr_b16 v[116:117], v35 offset:32768
    v_exp_f32 v60, v60
    v_exp_f32 v61, v61
    v_exp_f32 v62, v62
    v_exp_f32 v63, v63
    v_cvt_pk_bf16_f32 v124, v60, v61
    v_cvt_pk_bf16_f32 v125, v62, v63
    v_mfma_f32_32x32x16_bf16 v[44:59], v[112:115], v[20:23], v[44:59]
    ds_read_b64_tr_b16 v[118:119], v35 offset:33024
    v_exp_f32 v64, v64
    v_exp_f32 v65, v65
    v_exp_f32 v66, v66
    v_exp_f32 v67, v67
    v_cvt_pk_bf16_f32 v126, v64, v65
    v_cvt_pk_bf16_f32 v127, v66, v67
    v_mfma_f32_32x32x16_bf16 v[76:91], v[156:159], v[128:131], v[76:91]
    ds_read_b64_tr_b16 v[120:121], v35 offset:33280
    v_exp_f32 v68, v68
    v_exp_f32 v69, v69
    v_exp_f32 v70, v70
    v_exp_f32 v71, v71
    v_cvt_pk_bf16_f32 v128, v68, v69
    v_cvt_pk_bf16_f32 v129, v70, v71
    v_mfma_f32_32x32x16_bf16 v[92:107], v[152:155], v[124:127], v[92:107]
    ds_read_b64_tr_b16 v[122:123], v35 offset:33536
    v_exp_f32 v72, v72
    v_exp_f32 v73, v73
    v_exp_f32 v74, v74
    v_exp_f32 v75, v75
    v_cvt_pk_bf16_f32 v130, v72, v73
    v_cvt_pk_bf16_f32 v131, v74, v75
    v_mfma_f32_32x32x16_bf16 v[60:75], v[108:111], v[24:27], 0
    ds_read_b128 v[144:147], v33 offset:36864
    v_exp_f32 v44, v44
    v_exp_f32 v45, v45
    v_exp_f32 v46, v46
    v_exp_f32 v47, v47
    v_cvt_pk_bf16_f32 v124, v44, v45
    v_cvt_pk_bf16_f32 v125, v46, v47
    v_mfma_f32_32x32x16_bf16 v[60:75], v[112:115], v[28:31], v[60:75]
    ds_read_b128 v[148:151], v33 offset:37888
    v_exp_f32 v48, v48
    v_exp_f32 v49, v49
    v_exp_f32 v50, v50
    v_exp_f32 v51, v51
    v_cvt_pk_bf16_f32 v126, v48, v49
    v_cvt_pk_bf16_f32 v127, v50, v51
    v_mfma_f32_32x32x16_bf16 v[92:107], v[156:159], v[128:131], v[92:107]
    s_waitcnt lgkmcnt(2)
    v_exp_f32 v52, v52
    v_exp_f32 v53, v53
    v_exp_f32 v54, v54
    v_exp_f32 v55, v55
    v_cvt_pk_bf16_f32 v128, v52, v53
    v_cvt_pk_bf16_f32 v129, v54, v55
    v_mfma_f32_32x32x16_bf16 v[76:91], v[116:119], v[124:127], v[76:91]
    s_waitcnt lgkmcnt(0)
    v_exp_f32 v56, v56
    v_exp_f32 v57, v57
    v_exp_f32 v58, v58
    v_exp_f32 v59, v59
    v_cvt_pk_bf16_f32 v130, v56, v57
    v_cvt_pk_bf16_f32 v131, v58, v59
    v_mfma_f32_32x32x16_bf16 v[44:59], v[144:147], v[16:19], 0
    ds_read_b64_tr_b16 v[152:153], v35 offset:36864
    v_exp_f32 v60, v60
    v_exp_f32 v61, v61
    v_exp_f32 v62, v62
    v_exp_f32 v63, v63
    v_cvt_pk_bf16_f32 v124, v60, v61
    v_cvt_pk_bf16_f32 v125, v62, v63
    v_mfma_f32_32x32x16_bf16 v[44:59], v[148:151], v[20:23], v[44:59]
    ds_read_b64_tr_b16 v[154:155], v35 offset:37120
    v_exp_f32 v64, v64
    v_exp_f32 v65, v65
    v_exp_f32 v66, v66
    v_exp_f32 v67, v67
    v_cvt_pk_bf16_f32 v126, v64, v65
    v_cvt_pk_bf16_f32 v127, v66, v67
    v_mfma_f32_32x32x16_bf16 v[76:91], v[120:123], v[128:131], v[76:91]
    ds_read_b64_tr_b16 v[156:157], v35 offset:37376
    v_exp_f32 v68, v68
    v_exp_f32 v69, v69
    v_exp_f32 v70, v70
    v_exp_f32 v71, v71
    v_cvt_pk_bf16_f32 v128, v68, v69
    v_cvt_pk_bf16_f32 v129, v70, v71
    v_mfma_f32_32x32x16_bf16 v[92:107], v[116:119], v[124:127], v[92:107]
    ds_read_b64_tr_b16 v[158:159], v35 offset:37632
    v_exp_f32 v72, v72
    v_exp_f32 v73, v73
    v_exp_f32 v74, v74
    v_exp_f32 v75, v75
    v_cvt_pk_bf16_f32 v130, v72, v73
    v_cvt_pk_bf16_f32 v131, v74, v75
    v_mfma_f32_32x32x16_bf16 v[60:75], v[144:147], v[24:27], 0
    s_barrier
    ds_read_b128 v[108:111], v32 offset:0
    v_exp_f32 v44, v44
    v_exp_f32 v45, v45
    v_exp_f32 v46, v46
    v_exp_f32 v47, v47
    v_cvt_pk_bf16_f32 v124, v44, v45
    v_cvt_pk_bf16_f32 v125, v46, v47
    v_mfma_f32_32x32x16_bf16 v[60:75], v[148:151], v[28:31], v[60:75]
    ds_read_b128 v[112:115], v32 offset:1024
    v_exp_f32 v48, v48
    v_exp_f32 v49, v49
    v_exp_f32 v50, v50
    v_exp_f32 v51, v51
    v_cvt_pk_bf16_f32 v126, v48, v49
    v_cvt_pk_bf16_f32 v127, v50, v51
    v_mfma_f32_32x32x16_bf16 v[92:107], v[120:123], v[128:131], v[92:107]
    s_waitcnt lgkmcnt(2)
    v_exp_f32 v52, v52
    v_exp_f32 v53, v53
    v_exp_f32 v54, v54
    v_exp_f32 v55, v55
    v_cvt_pk_bf16_f32 v128, v52, v53
    v_cvt_pk_bf16_f32 v129, v54, v55
    v_mfma_f32_32x32x16_bf16 v[76:91], v[152:155], v[124:127], v[76:91]
    s_waitcnt lgkmcnt(0)
    v_exp_f32 v56, v56
    v_exp_f32 v57, v57
    v_exp_f32 v58, v58
    v_exp_f32 v59, v59
    v_cvt_pk_bf16_f32 v130, v56, v57
    v_cvt_pk_bf16_f32 v131, v58, v59
    v_mfma_f32_32x32x16_bf16 v[44:59], v[108:111], v[16:19], 0
    ds_read_b64_tr_b16 v[116:117], v34 offset:0
    v_exp_f32 v60, v60
    v_exp_f32 v61, v61
    v_exp_f32 v62, v62
    v_exp_f32 v63, v63
    v_cvt_pk_bf16_f32 v124, v60, v61
    v_cvt_pk_bf16_f32 v125, v62, v63
    v_mfma_f32_32x32x16_bf16 v[44:59], v[112:115], v[20:23], v[44:59]
    ds_read_b64_tr_b16 v[118:119], v34 offset:256
    v_exp_f32 v64, v64
    v_exp_f32 v65, v65
    v_exp_f32 v66, v66
    v_exp_f32 v67, v67
    v_cvt_pk_bf16_f32 v126, v64, v65
    v_cvt_pk_bf16_f32 v127, v66, v67
    v_mfma_f32_32x32x16_bf16 v[76:91], v[156:159], v[128:131], v[76:91]
    ds_read_b64_tr_b16 v[120:121], v34 offset:512
    v_exp_f32 v68, v68
    v_exp_f32 v69, v69
    v_exp_f32 v70, v70
    v_exp_f32 v71, v71
    v_cvt_pk_bf16_f32 v128, v68, v69
    v_cvt_pk_bf16_f32 v129, v70, v71
    v_mfma_f32_32x32x16_bf16 v[92:107], v[152:155], v[124:127], v[92:107]
    ds_read_b64_tr_b16 v[122:123], v34 offset:768
    v_exp_f32 v72, v72
    v_exp_f32 v73, v73
    v_exp_f32 v74, v74
    v_exp_f32 v75, v75
    v_cvt_pk_bf16_f32 v130, v72, v73
    v_cvt_pk_bf16_f32 v131, v74, v75
    v_mfma_f32_32x32x16_bf16 v[60:75], v[108:111], v[24:27], 0
    ds_read_b128 v[144:147], v32 offset:4096
    v_exp_f32 v44, v44
    v_exp_f32 v45, v45
    v_exp_f32 v46, v46
    v_exp_f32 v47, v47
    v_cvt_pk_bf16_f32 v124, v44, v45
    v_cvt_pk_bf16_f32 v125, v46, v47
    v_mfma_f32_32x32x16_bf16 v[60:75], v[112:115], v[28:31], v[60:75]
    ds_read_b128 v[148:151], v32 offset:5120
    v_exp_f32 v48, v48
    v_exp_f32 v49, v49
    v_exp_f32 v50, v50
    v_exp_f32 v51, v51
    v_cvt_pk_bf16_f32 v126, v48, v49
    v_cvt_pk_bf16_f32 v127, v50, v51
    v_mfma_f32_32x32x16_bf16 v[92:107], v[156:159], v[128:131], v[92:107]
    s_waitcnt lgkmcnt(2)
    v_exp_f32 v52, v52
    v_exp_f32 v53, v53
    v_exp_f32 v54, v54
    v_exp_f32 v55, v55
    v_cvt_pk_bf16_f32 v128, v52, v53
    v_cvt_pk_bf16_f32 v129, v54, v55
    v_mfma_f32_32x32x16_bf16 v[76:91], v[116:119], v[124:127], v[76:91]
    s_waitcnt lgkmcnt(0)
    v_exp_f32 v56, v56
    v_exp_f32 v57, v57
    v_exp_f32 v58, v58
    v_exp_f32 v59, v59
    v_cvt_pk_bf16_f32 v130, v56, v57
    v_cvt_pk_bf16_f32 v131, v58, v59
    v_mfma_f32_32x32x16_bf16 v[44:59], v[144:147], v[16:19], 0
    ds_read_b64_tr_b16 v[152:153], v34 offset:4096
    v_exp_f32 v60, v60
    v_exp_f32 v61, v61
    v_exp_f32 v62, v62
    v_exp_f32 v63, v63
    v_cvt_pk_bf16_f32 v124, v60, v61
    v_cvt_pk_bf16_f32 v125, v62, v63
    v_mfma_f32_32x32x16_bf16 v[44:59], v[148:151], v[20:23], v[44:59]
    ds_read_b64_tr_b16 v[154:155], v34 offset:4352
    v_exp_f32 v64, v64
    v_exp_f32 v65, v65
    v_exp_f32 v66, v66
    v_exp_f32 v67, v67
    v_cvt_pk_bf16_f32 v126, v64, v65
    v_cvt_pk_bf16_f32 v127, v66, v67
    v_mfma_f32_32x32x16_bf16 v[76:91], v[120:123], v[128:131], v[76:91]
    ds_read_b64_tr_b16 v[156:157], v34 offset:4608
    v_exp_f32 v68, v68
    v_exp_f32 v69, v69
    v_exp_f32 v70, v70
    v_exp_f32 v71, v71
    v_cvt_pk_bf16_f32 v128, v68, v69
    v_cvt_pk_bf16_f32 v129, v70, v71
    v_mfma_f32_32x32x16_bf16 v[92:107], v[116:119], v[124:127], v[92:107]
    ds_read_b64_tr_b16 v[158:159], v34 offset:4864
    v_exp_f32 v72, v72
    v_exp_f32 v73, v73
    v_exp_f32 v74, v74
    v_exp_f32 v75, v75
    v_cvt_pk_bf16_f32 v130, v72, v73
    v_cvt_pk_bf16_f32 v131, v74, v75
    v_mfma_f32_32x32x16_bf16 v[60:75], v[144:147], v[24:27], 0
    s_barrier
    ds_read_b128 v[108:111], v32 offset:32768
    v_exp_f32 v44, v44
    v_exp_f32 v45, v45
    v_exp_f32 v46, v46
    v_exp_f32 v47, v47
    v_cvt_pk_bf16_f32 v124, v44, v45
    v_cvt_pk_bf16_f32 v125, v46, v47
    v_mfma_f32_32x32x16_bf16 v[60:75], v[148:151], v[28:31], v[60:75]
    ds_read_b128 v[112:115], v32 offset:33792
    v_exp_f32 v48, v48
    v_exp_f32 v49, v49
    v_exp_f32 v50, v50
    v_exp_f32 v51, v51
    v_cvt_pk_bf16_f32 v126, v48, v49
    v_cvt_pk_bf16_f32 v127, v50, v51
    v_mfma_f32_32x32x16_bf16 v[92:107], v[120:123], v[128:131], v[92:107]
    s_waitcnt lgkmcnt(2)
    v_exp_f32 v52, v52
    v_exp_f32 v53, v53
    v_exp_f32 v54, v54
    v_exp_f32 v55, v55
    v_cvt_pk_bf16_f32 v128, v52, v53
    v_cvt_pk_bf16_f32 v129, v54, v55
    v_mfma_f32_32x32x16_bf16 v[76:91], v[152:155], v[124:127], v[76:91]
    s_waitcnt lgkmcnt(0)
    v_exp_f32 v56, v56
    v_exp_f32 v57, v57
    v_exp_f32 v58, v58
    v_exp_f32 v59, v59
    v_cvt_pk_bf16_f32 v130, v56, v57
    v_cvt_pk_bf16_f32 v131, v58, v59
    v_mfma_f32_32x32x16_bf16 v[44:59], v[108:111], v[16:19], 0
    ds_read_b64_tr_b16 v[116:117], v34 offset:32768
    v_exp_f32 v60, v60
    v_exp_f32 v61, v61
    v_exp_f32 v62, v62
    v_exp_f32 v63, v63
    v_cvt_pk_bf16_f32 v124, v60, v61
    v_cvt_pk_bf16_f32 v125, v62, v63
    v_mfma_f32_32x32x16_bf16 v[44:59], v[112:115], v[20:23], v[44:59]
    ds_read_b64_tr_b16 v[118:119], v34 offset:33024
    v_exp_f32 v64, v64
    v_exp_f32 v65, v65
    v_exp_f32 v66, v66
    v_exp_f32 v67, v67
    v_cvt_pk_bf16_f32 v126, v64, v65
    v_cvt_pk_bf16_f32 v127, v66, v67
    v_mfma_f32_32x32x16_bf16 v[76:91], v[156:159], v[128:131], v[76:91]
    ds_read_b64_tr_b16 v[120:121], v34 offset:33280
    v_exp_f32 v68, v68
    v_exp_f32 v69, v69
    v_exp_f32 v70, v70
    v_exp_f32 v71, v71
    v_cvt_pk_bf16_f32 v128, v68, v69
    v_cvt_pk_bf16_f32 v129, v70, v71
    v_mfma_f32_32x32x16_bf16 v[92:107], v[152:155], v[124:127], v[92:107]
    ds_read_b64_tr_b16 v[122:123], v34 offset:33536
    v_exp_f32 v72, v72
    v_exp_f32 v73, v73
    v_exp_f32 v74, v74
    v_exp_f32 v75, v75
    v_cvt_pk_bf16_f32 v130, v72, v73
    v_cvt_pk_bf16_f32 v131, v74, v75
    v_mfma_f32_32x32x16_bf16 v[60:75], v[108:111], v[24:27], 0
    ds_read_b128 v[144:147], v32 offset:36864
    v_exp_f32 v44, v44
    v_exp_f32 v45, v45
    v_exp_f32 v46, v46
    v_exp_f32 v47, v47
    v_cvt_pk_bf16_f32 v124, v44, v45
    v_cvt_pk_bf16_f32 v125, v46, v47
    v_mfma_f32_32x32x16_bf16 v[60:75], v[112:115], v[28:31], v[60:75]
    ds_read_b128 v[148:151], v32 offset:37888
    v_exp_f32 v48, v48
    v_exp_f32 v49, v49
    v_exp_f32 v50, v50
    v_exp_f32 v51, v51
    v_cvt_pk_bf16_f32 v126, v48, v49
    v_cvt_pk_bf16_f32 v127, v50, v51
    v_mfma_f32_32x32x16_bf16 v[92:107], v[156:159], v[128:131], v[92:107]
    s_waitcnt lgkmcnt(2)
    v_exp_f32 v52, v52
    v_exp_f32 v53, v53
    v_exp_f32 v54, v54
    v_exp_f32 v55, v55
    v_cvt_pk_bf16_f32 v128, v52, v53
    v_cvt_pk_bf16_f32 v129, v54, v55
    v_mfma_f32_32x32x16_bf16 v[76:91], v[116:119], v[124:127], v[76:91]
    s_waitcnt lgkmcnt(0)
    v_exp_f32 v56, v56
    v_exp_f32 v57, v57
    v_exp_f32 v58, v58
    v_exp_f32 v59, v59
    v_cvt_pk_bf16_f32 v130, v56, v57
    v_cvt_pk_bf16_f32 v131, v58, v59
    v_mfma_f32_32x32x16_bf16 v[44:59], v[144:147], v[16:19], 0
    ds_read_b64_tr_b16 v[152:153], v34 offset:36864
    v_exp_f32 v60, v60
    v_exp_f32 v61, v61
    v_exp_f32 v62, v62
    v_exp_f32 v63, v63
    v_cvt_pk_bf16_f32 v124, v60, v61
    v_cvt_pk_bf16_f32 v125, v62, v63
    v_mfma_f32_32x32x16_bf16 v[44:59], v[148:151], v[20:23], v[44:59]
    ds_read_b64_tr_b16 v[154:155], v34 offset:37120
    v_exp_f32 v64, v64
    v_exp_f32 v65, v65
    v_exp_f32 v66, v66
    v_exp_f32 v67, v67
    v_cvt_pk_bf16_f32 v126, v64, v65
    v_cvt_pk_bf16_f32 v127, v66, v67
    v_mfma_f32_32x32x16_bf16 v[76:91], v[120:123], v[128:131], v[76:91]
    ds_read_b64_tr_b16 v[156:157], v34 offset:37376
    v_exp_f32 v68, v68
    v_exp_f32 v69, v69
    v_exp_f32 v70, v70
    v_exp_f32 v71, v71
    v_cvt_pk_bf16_f32 v128, v68, v69
    v_cvt_pk_bf16_f32 v129, v70, v71
    v_mfma_f32_32x32x16_bf16 v[92:107], v[116:119], v[124:127], v[92:107]
    ds_read_b64_tr_b16 v[158:159], v34 offset:37632
    v_exp_f32 v72, v72
    v_exp_f32 v73, v73
    v_exp_f32 v74, v74
    v_exp_f32 v75, v75
    v_cvt_pk_bf16_f32 v130, v72, v73
    v_cvt_pk_bf16_f32 v131, v74, v75
    v_mfma_f32_32x32x16_bf16 v[60:75], v[144:147], v[24:27], 0
    s_barrier
    ds_read_b128 v[108:111], v33 offset:0
    v_exp_f32 v44, v44
    v_exp_f32 v45, v45
    v_exp_f32 v46, v46
    v_exp_f32 v47, v47
    v_cvt_pk_bf16_f32 v124, v44, v45
    v_cvt_pk_bf16_f32 v125, v46, v47
    v_mfma_f32_32x32x16_bf16 v[60:75], v[148:151], v[28:31], v[60:75]
    ds_read_b128 v[112:115], v33 offset:1024
    v_exp_f32 v48, v48
    v_exp_f32 v49, v49
    v_exp_f32 v50, v50
    v_exp_f32 v51, v51
    v_cvt_pk_bf16_f32 v126, v48, v49
    v_cvt_pk_bf16_f32 v127, v50, v51
    v_mfma_f32_32x32x16_bf16 v[92:107], v[120:123], v[128:131], v[92:107]
    s_waitcnt lgkmcnt(2)
    v_exp_f32 v52, v52
    v_exp_f32 v53, v53
    v_exp_f32 v54, v54
    v_exp_f32 v55, v55
    v_cvt_pk_bf16_f32 v128, v52, v53
    v_cvt_pk_bf16_f32 v129, v54, v55
    v_mfma_f32_32x32x16_bf16 v[76:91], v[152:155], v[124:127], v[76:91]
    s_waitcnt lgkmcnt(0)
    v_exp_f32 v56, v56
    v_exp_f32 v57, v57
    v_exp_f32 v58, v58
    v_exp_f32 v59, v59
    v_cvt_pk_bf16_f32 v130, v56, v57
    v_cvt_pk_bf16_f32 v131, v58, v59
    v_mfma_f32_32x32x16_bf16 v[44:59], v[108:111], v[16:19], 0
    ds_read_b64_tr_b16 v[116:117], v35 offset:0
    v_exp_f32 v60, v60
    v_exp_f32 v61, v61
    v_exp_f32 v62, v62
    v_exp_f32 v63, v63
    v_cvt_pk_bf16_f32 v124, v60, v61
    v_cvt_pk_bf16_f32 v125, v62, v63
    v_mfma_f32_32x32x16_bf16 v[44:59], v[112:115], v[20:23], v[44:59]
    ds_read_b64_tr_b16 v[118:119], v35 offset:256
    v_exp_f32 v64, v64
    v_exp_f32 v65, v65
    v_exp_f32 v66, v66
    v_exp_f32 v67, v67
    v_cvt_pk_bf16_f32 v126, v64, v65
    v_cvt_pk_bf16_f32 v127, v66, v67
    v_mfma_f32_32x32x16_bf16 v[76:91], v[156:159], v[128:131], v[76:91]
    ds_read_b64_tr_b16 v[120:121], v35 offset:512
    v_exp_f32 v68, v68
    v_exp_f32 v69, v69
    v_exp_f32 v70, v70
    v_exp_f32 v71, v71
    v_cvt_pk_bf16_f32 v128, v68, v69
    v_cvt_pk_bf16_f32 v129, v70, v71
    v_mfma_f32_32x32x16_bf16 v[92:107], v[152:155], v[124:127], v[92:107]
    ds_read_b64_tr_b16 v[122:123], v35 offset:768
    v_exp_f32 v72, v72
    v_exp_f32 v73, v73
    v_exp_f32 v74, v74
    v_exp_f32 v75, v75
    v_cvt_pk_bf16_f32 v130, v72, v73
    v_cvt_pk_bf16_f32 v131, v74, v75
    v_mfma_f32_32x32x16_bf16 v[60:75], v[108:111], v[24:27], 0
    ds_read_b128 v[144:147], v33 offset:4096
    v_exp_f32 v44, v44
    v_exp_f32 v45, v45
    v_exp_f32 v46, v46
    v_exp_f32 v47, v47
    v_cvt_pk_bf16_f32 v124, v44, v45
    v_cvt_pk_bf16_f32 v125, v46, v47
    v_mfma_f32_32x32x16_bf16 v[60:75], v[112:115], v[28:31], v[60:75]
    ds_read_b128 v[148:151], v33 offset:5120
    v_exp_f32 v48, v48
    v_exp_f32 v49, v49
    v_exp_f32 v50, v50
    v_exp_f32 v51, v51
    v_cvt_pk_bf16_f32 v126, v48, v49
    v_cvt_pk_bf16_f32 v127, v50, v51
    v_mfma_f32_32x32x16_bf16 v[92:107], v[156:159], v[128:131], v[92:107]
    s_waitcnt lgkmcnt(2)
    v_exp_f32 v52, v52
    v_exp_f32 v53, v53
    v_exp_f32 v54, v54
    v_exp_f32 v55, v55
    v_cvt_pk_bf16_f32 v128, v52, v53
    v_cvt_pk_bf16_f32 v129, v54, v55
    v_mfma_f32_32x32x16_bf16 v[76:91], v[116:119], v[124:127], v[76:91]
    s_waitcnt lgkmcnt(0)
    v_exp_f32 v56, v56
    v_exp_f32 v57, v57
    v_exp_f32 v58, v58
    v_exp_f32 v59, v59
    v_cvt_pk_bf16_f32 v130, v56, v57
    v_cvt_pk_bf16_f32 v131, v58, v59
    v_mfma_f32_32x32x16_bf16 v[44:59], v[144:147], v[16:19], 0
    ds_read_b64_tr_b16 v[152:153], v35 offset:4096
    v_exp_f32 v60, v60
    v_exp_f32 v61, v61
    v_exp_f32 v62, v62
    v_exp_f32 v63, v63
    v_cvt_pk_bf16_f32 v124, v60, v61
    v_cvt_pk_bf16_f32 v125, v62, v63
    v_mfma_f32_32x32x16_bf16 v[44:59], v[148:151], v[20:23], v[44:59]
    ds_read_b64_tr_b16 v[154:155], v35 offset:4352
    v_exp_f32 v64, v64
    v_exp_f32 v65, v65
    v_exp_f32 v66, v66
    v_exp_f32 v67, v67
    v_cvt_pk_bf16_f32 v126, v64, v65
    v_cvt_pk_bf16_f32 v127, v66, v67
    v_mfma_f32_32x32x16_bf16 v[76:91], v[120:123], v[128:131], v[76:91]
    ds_read_b64_tr_b16 v[156:157], v35 offset:4608
    v_exp_f32 v68, v68
    v_exp_f32 v69, v69
    v_exp_f32 v70, v70
    v_exp_f32 v71, v71
    v_cvt_pk_bf16_f32 v128, v68, v69
    v_cvt_pk_bf16_f32 v129, v70, v71
    v_mfma_f32_32x32x16_bf16 v[92:107], v[116:119], v[124:127], v[92:107]
    ds_read_b64_tr_b16 v[158:159], v35 offset:4864
    v_exp_f32 v72, v72
    v_exp_f32 v73, v73
    v_exp_f32 v74, v74
    v_exp_f32 v75, v75
    v_cvt_pk_bf16_f32 v130, v72, v73
    v_cvt_pk_bf16_f32 v131, v74, v75
    v_mfma_f32_32x32x16_bf16 v[60:75], v[144:147], v[24:27], 0
    s_barrier
    ds_read_b128 v[108:111], v33 offset:32768
    v_exp_f32 v44, v44
    v_exp_f32 v45, v45
    v_exp_f32 v46, v46
    v_exp_f32 v47, v47
    v_cvt_pk_bf16_f32 v124, v44, v45
    v_cvt_pk_bf16_f32 v125, v46, v47
    v_mfma_f32_32x32x16_bf16 v[60:75], v[148:151], v[28:31], v[60:75]
    ds_read_b128 v[112:115], v33 offset:33792
    v_exp_f32 v48, v48
    v_exp_f32 v49, v49
    v_exp_f32 v50, v50
    v_exp_f32 v51, v51
    v_cvt_pk_bf16_f32 v126, v48, v49
    v_cvt_pk_bf16_f32 v127, v50, v51
    v_mfma_f32_32x32x16_bf16 v[92:107], v[120:123], v[128:131], v[92:107]
    s_waitcnt lgkmcnt(2)
    v_exp_f32 v52, v52
    v_exp_f32 v53, v53
    v_exp_f32 v54, v54
    v_exp_f32 v55, v55
    v_cvt_pk_bf16_f32 v128, v52, v53
    v_cvt_pk_bf16_f32 v129, v54, v55
    v_mfma_f32_32x32x16_bf16 v[76:91], v[152:155], v[124:127], v[76:91]
    s_waitcnt lgkmcnt(0)
    v_exp_f32 v56, v56
    v_exp_f32 v57, v57
    v_exp_f32 v58, v58
    v_exp_f32 v59, v59
    v_cvt_pk_bf16_f32 v130, v56, v57
    v_cvt_pk_bf16_f32 v131, v58, v59
    v_mfma_f32_32x32x16_bf16 v[44:59], v[108:111], v[16:19], 0
    ds_read_b64_tr_b16 v[116:117], v35 offset:32768
    v_exp_f32 v60, v60
    v_exp_f32 v61, v61
    v_exp_f32 v62, v62
    v_exp_f32 v63, v63
    v_cvt_pk_bf16_f32 v124, v60, v61
    v_cvt_pk_bf16_f32 v125, v62, v63
    v_mfma_f32_32x32x16_bf16 v[44:59], v[112:115], v[20:23], v[44:59]
    ds_read_b64_tr_b16 v[118:119], v35 offset:33024
    v_exp_f32 v64, v64
    v_exp_f32 v65, v65
    v_exp_f32 v66, v66
    v_exp_f32 v67, v67
    v_cvt_pk_bf16_f32 v126, v64, v65
    v_cvt_pk_bf16_f32 v127, v66, v67
    v_mfma_f32_32x32x16_bf16 v[76:91], v[156:159], v[128:131], v[76:91]
    ds_read_b64_tr_b16 v[120:121], v35 offset:33280
    v_exp_f32 v68, v68
    v_exp_f32 v69, v69
    v_exp_f32 v70, v70
    v_exp_f32 v71, v71
    v_cvt_pk_bf16_f32 v128, v68, v69
    v_cvt_pk_bf16_f32 v129, v70, v71
    v_mfma_f32_32x32x16_bf16 v[92:107], v[152:155], v[124:127], v[92:107]
    ds_read_b64_tr_b16 v[122:123], v35 offset:33536
    v_exp_f32 v72, v72
    v_exp_f32 v73, v73
    v_exp_f32 v74, v74
    v_exp_f32 v75, v75
    v_cvt_pk_bf16_f32 v130, v72, v73
    v_cvt_pk_bf16_f32 v131, v74, v75
    v_mfma_f32_32x32x16_bf16 v[60:75], v[108:111], v[24:27], 0
    ds_read_b128 v[144:147], v33 offset:36864
    v_exp_f32 v44, v44
    v_exp_f32 v45, v45
    v_exp_f32 v46, v46
    v_exp_f32 v47, v47
    v_cvt_pk_bf16_f32 v124, v44, v45
    v_cvt_pk_bf16_f32 v125, v46, v47
    v_mfma_f32_32x32x16_bf16 v[60:75], v[112:115], v[28:31], v[60:75]
    ds_read_b128 v[148:151], v33 offset:37888
    v_exp_f32 v48, v48
    v_exp_f32 v49, v49
    v_exp_f32 v50, v50
    v_exp_f32 v51, v51
    v_cvt_pk_bf16_f32 v126, v48, v49
    v_cvt_pk_bf16_f32 v127, v50, v51
    v_mfma_f32_32x32x16_bf16 v[92:107], v[156:159], v[128:131], v[92:107]
    s_waitcnt lgkmcnt(2)
    v_exp_f32 v52, v52
    v_exp_f32 v53, v53
    v_exp_f32 v54, v54
    v_exp_f32 v55, v55
    v_cvt_pk_bf16_f32 v128, v52, v53
    v_cvt_pk_bf16_f32 v129, v54, v55
    v_mfma_f32_32x32x16_bf16 v[76:91], v[116:119], v[124:127], v[76:91]
    s_waitcnt lgkmcnt(0)
    v_exp_f32 v56, v56
    v_exp_f32 v57, v57
    v_exp_f32 v58, v58
    v_exp_f32 v59, v59
    v_cvt_pk_bf16_f32 v130, v56, v57
    v_cvt_pk_bf16_f32 v131, v58, v59
    v_mfma_f32_32x32x16_bf16 v[44:59], v[144:147], v[16:19], 0
    ds_read_b64_tr_b16 v[152:153], v35 offset:36864
    v_exp_f32 v60, v60
    v_exp_f32 v61, v61
    v_exp_f32 v62, v62
    v_exp_f32 v63, v63
    v_cvt_pk_bf16_f32 v124, v60, v61
    v_cvt_pk_bf16_f32 v125, v62, v63
    v_mfma_f32_32x32x16_bf16 v[44:59], v[148:151], v[20:23], v[44:59]
    ds_read_b64_tr_b16 v[154:155], v35 offset:37120
    v_exp_f32 v64, v64
    v_exp_f32 v65, v65
    v_exp_f32 v66, v66
    v_exp_f32 v67, v67
    v_cvt_pk_bf16_f32 v126, v64, v65
    v_cvt_pk_bf16_f32 v127, v66, v67
    v_mfma_f32_32x32x16_bf16 v[76:91], v[120:123], v[128:131], v[76:91]
    ds_read_b64_tr_b16 v[156:157], v35 offset:37376
    v_exp_f32 v68, v68
    v_exp_f32 v69, v69
    v_exp_f32 v70, v70
    v_exp_f32 v71, v71
    v_cvt_pk_bf16_f32 v128, v68, v69
    v_cvt_pk_bf16_f32 v129, v70, v71
    v_mfma_f32_32x32x16_bf16 v[92:107], v[116:119], v[124:127], v[92:107]
    ds_read_b64_tr_b16 v[158:159], v35 offset:37632
    v_exp_f32 v72, v72
    v_exp_f32 v73, v73
    v_exp_f32 v74, v74
    v_exp_f32 v75, v75
    v_cvt_pk_bf16_f32 v130, v72, v73
    v_cvt_pk_bf16_f32 v131, v74, v75
    v_mfma_f32_32x32x16_bf16 v[60:75], v[144:147], v[24:27], 0
    s_barrier
    v_exp_f32 v44, v44
    v_exp_f32 v45, v45
    v_exp_f32 v46, v46
    v_exp_f32 v47, v47
    v_cvt_pk_bf16_f32 v124, v44, v45
    v_cvt_pk_bf16_f32 v125, v46, v47
    v_mfma_f32_32x32x16_bf16 v[60:75], v[148:151], v[28:31], v[60:75]
    v_exp_f32 v48, v48
    v_exp_f32 v49, v49
    v_exp_f32 v50, v50
    v_exp_f32 v51, v51
    v_cvt_pk_bf16_f32 v126, v48, v49
    v_cvt_pk_bf16_f32 v127, v50, v51
    v_mfma_f32_32x32x16_bf16 v[92:107], v[120:123], v[128:131], v[92:107]
    s_waitcnt lgkmcnt(0)
    v_exp_f32 v52, v52
    v_exp_f32 v53, v53
    v_exp_f32 v54, v54
    v_exp_f32 v55, v55
    v_cvt_pk_bf16_f32 v128, v52, v53
    v_cvt_pk_bf16_f32 v129, v54, v55
    v_mfma_f32_32x32x16_bf16 v[76:91], v[152:155], v[124:127], v[76:91]
    v_exp_f32 v56, v56
    v_exp_f32 v57, v57
    v_exp_f32 v58, v58
    v_exp_f32 v59, v59
    v_cvt_pk_bf16_f32 v130, v56, v57
    v_cvt_pk_bf16_f32 v131, v58, v59
    v_exp_f32 v60, v60
    v_exp_f32 v61, v61
    v_exp_f32 v62, v62
    v_exp_f32 v63, v63
    v_cvt_pk_bf16_f32 v124, v60, v61
    v_cvt_pk_bf16_f32 v125, v62, v63
    v_exp_f32 v64, v64
    v_exp_f32 v65, v65
    v_exp_f32 v66, v66
    v_exp_f32 v67, v67
    v_cvt_pk_bf16_f32 v126, v64, v65
    v_cvt_pk_bf16_f32 v127, v66, v67
    v_mfma_f32_32x32x16_bf16 v[76:91], v[156:159], v[128:131], v[76:91]
    v_exp_f32 v68, v68
    v_exp_f32 v69, v69
    v_exp_f32 v70, v70
    v_exp_f32 v71, v71
    v_cvt_pk_bf16_f32 v128, v68, v69
    v_cvt_pk_bf16_f32 v129, v70, v71
    v_mfma_f32_32x32x16_bf16 v[92:107], v[152:155], v[124:127], v[92:107]
    v_exp_f32 v72, v72
    v_exp_f32 v73, v73
    v_exp_f32 v74, v74
    v_exp_f32 v75, v75
    v_mov_b32 v120, v156
    v_mov_b32 v121, v157
    v_mov_b32 v122, v158
    v_mov_b32 v123, v159
MAINE_sequential_preLN__softmax_full_mha__glu_gated_reglu__prompt_kernel_24:
    s_nop 0
    v_cvt_pk_bf16_f32 v130, v72, v73
    v_cvt_pk_bf16_f32 v131, v74, v75
    v_cndmask_b32 v44, v88, v80, s[62:63]
    ds_write_b128 v38, v[84:87]
    v_mfma_f32_32x32x16_bf16 v[92:107], v[120:123], v[128:131], v[92:107]
    ds_write_b128 v38, v[88:91] offset:1024
    ds_write_b32 v38, v44 offset:6144
    v_max_f32 v132, |v76|, |v77|
    v_max3_f32 v132, v132, |v78|, |v79|
    v_max3_f32 v132, v132, |v80|, |v81|
    v_max3_f32 v132, v132, |v82|, |v83|
    v_max3_f32 v132, v132, |v84|, |v85|
    v_max3_f32 v132, v132, |v86|, |v87|
    v_max3_f32 v132, v132, |v88|, |v89|
    v_max3_f32 v132, v132, |v90|, |v91|
    s_nop 1
    v_cndmask_b32 v45, v104, v96, s[62:63]
    ds_write_b128 v39, v[92:95]
    ds_write_b128 v39, v[96:99] offset:1024
    ds_write_b32 v39, v45 offset:4100
    ds_write_b128 v40, v[100:103]
    ds_write_b128 v40, v[104:107] offset:1024
    ds_write_b32 v40, v45 offset:2056
    v_max3_f32 v132, v132, |v92|, |v93|
    v_max3_f32 v132, v132, |v94|, |v95|
    v_max3_f32 v132, v132, |v96|, |v97|
    v_max3_f32 v132, v132, |v98|, |v99|
    v_max3_f32 v132, v132, |v100|, |v101|
    v_max3_f32 v132, v132, |v102|, |v103|
    v_max3_f32 v132, v132, |v104|, |v105|
    v_max3_f32 v132, v132, |v106|, |v107|
    v_min_f32 v134, v44, v45
    v_cmp_nlt_f32 vcc, s60, v134
    v_mov_b32 v135, 0x7b800000
    v_cmp_nlt_f32 s[48:49], v132, v135
    s_lshl_b32 s51, s28, 2
    s_add_u32 s51, s51, 131072
    s_or_b32 s48, s48, s49
    s_or_b32 s48, s48, vcc_hi
    v_mov_b32 v134, s48
    v_mov_b32 v135, s51
    ds_write_b32 v135, v134
    s_waitcnt vmcnt(8) lgkmcnt(0)
    s_setprio 0
    s_barrier
    ds_read_b128 v[48:51], v37 offset:6144
    ds_read_b32 v134, v41
    ds_read_b128 v[60:63], v37 offset:0
    ds_read_b128 v[64:67], v37 offset:1024
    ds_read_b128 v[68:71], v37 offset:2048
    ds_read_b128 v[72:75], v37 offset:3072
    ds_read_b128 v[108:111], v37 offset:4096
    ds_read_b128 v[112:115], v37 offset:5120
    s_waitcnt lgkmcnt(6)
    v_add_f32 v44, v44, v48
    v_add_f32 v49, v49, v50
    v_cmp_ne_u32 vcc, 0, v134
    v_add_f32 v44, v44, v49
    v_mov_b32 v45, v44
    s_cmp_lg_u32 s56, 0
    s_cbranch_scc1 ST_sequential_preLN__softmax_full_mha__glu_gated_reglu__prompt_kernel_35
    s_cbranch_vccnz SLOW_sequential_preLN__softmax_full_mha__glu_gated_reglu__prompt_kernel_34
ST_sequential_preLN__softmax_full_mha__glu_gated_reglu__prompt_kernel_35:
    v_permlane32_swap_b32 v44, v45
    v_rcp_f32 v44, v45
    s_waitcnt lgkmcnt(4)
    v_add_f32 v76, v76, v60
    v_add_f32 v77, v77, v61
    v_add_f32 v78, v78, v62
    v_add_f32 v79, v79, v63
    v_add_f32 v80, v80, v64
    v_add_f32 v81, v81, v65
    v_add_f32 v82, v82, v66
    v_add_f32 v83, v83, v67
    s_waitcnt lgkmcnt(2)
    v_add_f32 v76, v76, v68
    v_add_f32 v77, v77, v69
    v_add_f32 v78, v78, v70
    v_add_f32 v79, v79, v71
    v_add_f32 v80, v80, v72
    v_add_f32 v81, v81, v73
    v_add_f32 v82, v82, v74
    v_add_f32 v83, v83, v75
    s_waitcnt lgkmcnt(0)
    v_add_f32 v76, v76, v108
    v_add_f32 v77, v77, v109
    v_add_f32 v78, v78, v110
    v_add_f32 v79, v79, v111
    v_add_f32 v80, v80, v112
    v_add_f32 v81, v81, v113
    v_add_f32 v82, v82, v114
    v_add_f32 v83, v83, v115
    v_mul_f32 v76, v76, v44
    v_mul_f32 v77, v77, v44
    v_mul_f32 v78, v78, v44
    v_mul_f32 v79, v79, v44
    v_mul_f32 v80, v80, v44
    v_mul_f32 v81, v81, v44
    v_mul_f32 v82, v82, v44
    v_mul_f32 v83, v83, v44
    v_cvt_pk_bf16_f32 v124, v76, v77
    v_cvt_pk_bf16_f32 v125, v78, v79
    v_cvt_pk_bf16_f32 v126, v80, v81
    v_cvt_pk_bf16_f32 v127, v82, v83
    buffer_store_dwordx4 v[124:127], v2, s[24:27], s59 offen sc1
    s_mov_b32 s36, s42
    s_lshl_b32 s37, s43, 8
    s_add_u32 s37, s37, s36
    s_lshl_b32 s37, s37, 3
    s_add_u32 s37, s37, 23592960
    v_lshlrev_b32 v8, 7, v1
    s_waitcnt vmcnt(0)
    v_mov_b32 v6, 163780
    v_mov_b32 v7, 1
    s_mov_b64 exec, 1
    ds_add_rtn_u32 v7, v6, v7
    s_waitcnt lgkmcnt(0)
    v_readfirstlane_b32 s34, v7
    s_mov_b64 exec, -1
    s_cmp_lg_u32 s34, 7
    s_cbranch_scc1 AR_sequential_preLN__softmax_full_mha__glu_gated_reglu__prompt_kernel_36
    s_mov_b64 exec, 0x7f7f
    buffer_store_dwordx2 v[4:5], v8, s[24:27], s37 offen sc1
    s_mov_b64 exec, -1
AR_sequential_preLN__softmax_full_mha__glu_gated_reglu__prompt_kernel_36:
    s_cmp_lg_u32 s28, 7
    s_cbranch_scc1 FX_sequential_preLN__softmax_full_mha__glu_gated_reglu__prompt_kernel_37
    s_mov_b32 s35, 23695360
    buffer_load_dwordx4 v[60:63], v2, s[24:27], s35 offen sc1
    buffer_load_dwordx4 v[64:67], v2, s[24:27], s35 offen offset:1024 sc1
    s_mov_b32 s34, 0
FC_sequential_preLN__softmax_full_mha__glu_gated_reglu__prompt_kernel_38:
    s_waitcnt vmcnt(0)
    v_cmp_ne_u64 vcc, v[60:61], v[4:5]
    v_cmp_ne_u64 s[36:37], v[62:63], v[4:5]
    s_nop 0
    s_or_b64 vcc, vcc, s[36:37]
    v_cmp_ne_u64 s[36:37], v[64:65], v[4:5]
    s_nop 0
    s_or_b64 vcc, vcc, s[36:37]
    v_cmp_ne_u64 s[36:37], v[66:67], v[4:5]
    s_nop 0
    s_or_b64 vcc, vcc, s[36:37]
    s_cbranch_scc0 FX_sequential_preLN__softmax_full_mha__glu_gated_reglu__prompt_kernel_37
    s_add_u32 s34, s34, 1
    s_cmp_gt_u32 s34, 65536
    s_cbranch_scc1 FX_sequential_preLN__softmax_full_mha__glu_gated_reglu__prompt_kernel_37
    s_sleep 8
    s_mov_b32 s35, 23695360
    buffer_load_dwordx4 v[60:63], v2, s[24:27], s35 offen sc1
    buffer_load_dwordx4 v[64:67], v2, s[24:27], s35 offen offset:1024 sc1
    s_branch FC_sequential_preLN__softmax_full_mha__glu_gated_reglu__prompt_kernel_38
FX_sequential_preLN__softmax_full_mha__glu_gated_reglu__prompt_kernel_37:
    s_and_b32 s51, s2, 1
    s_lshl_b32 s51, s51, 3
    s_bfe_u32 s52, s2, 0x30003
    s_add_u32 s38, s51, s52
    s_bfe_u32 s51, s2, 0x20001
    s_lshl_b32 s51, s51, 2
    s_lshr_b32 s52, s2, 6
    s_add_u32 s39, s51, s52
    s_mul_i32 s41, s29, 7680
    s_mul_i32 s40, s39, 215040
    s_add_u32 s40, s40, s41
    s_add_u32 s40, s40, 19628032
    s_barrier
    s_cmp_ge_u32 s2, 224
    s_cbranch_scc1 P35X_sequential_preLN__softmax_full_mha__glu_gated_reglu__prompt_kernel_39
    s_and_b32 s51, s2, 7
    s_lshl_b32 s51, s51, 2
    s_bfe_u32 s52, s2, 0x20003
    s_add_u32 s48, s51, s52
    s_lshr_b32 s49, s2, 5
    s_lshr_b32 s50, s28, 2
    s_and_b32 s51, s29, 1
    s_lshl_b32 s51, s51, 8
    v_xor_b32 v16, s51, v2
    s_lshl_b32 s58, s50, 1
    s_and_b32 s51, s29, 1
    s_add_u32 s58, s58, s51
    s_xor_b32 s51, s50, 0
    s_lshl_b32 s51, s51, 2
    s_add_u32 s51, s51, s58
    s_lshl_b32 s51, s51, 12
    v_add_u32 v18, s51, v16
    s_xor_b32 s51, s50, 1
    s_lshl_b32 s51, s51, 2
    s_add_u32 s51, s51, s58
    s_lshl_b32 s51, s51, 12
    v_add_u32 v19, s51, v16
    ds_read_b128 v[92:95], v18 offset:0
    ds_read_b128 v[96:99], v19 offset:0
    ds_read_b128 v[100:103], v18 offset:1024
    ds_read_b128 v[104:107], v19 offset:1024
    ds_read_b128 v[108:111], v18 offset:2048
    ds_read_b128 v[112:115], v19 offset:2048
    ds_read_b128 v[116:119], v18 offset:3072
    ds_read_b128 v[120:123], v19 offset:3072
    ds_read_b128 v[124:127], v18 offset:32768
    ds_read_b128 v[128:131], v19 offset:32768
    v_lshrrev_b32 v22, 5, v1
    v_and_b32 v23, 31, v1
    v_lshlrev_b32 v24, 10, v22
    v_lshl_add_u32 v24, v23, 4, v24
    v_mul_u32_u24 v25, 896, v23
    v_lshl_add_u32 v25, v22, 5, v25
    s_lshl_b32 s51, s48, 1
    s_lshr_b32 s52, s29, 1
    s_add_u32 s51, s51, s52
    s_lshl_b32 s52, s49, 3
    s_lshl_b32 s53, s50, 2
    s_add_u32 s52, s52, s53
    s_and_b32 s53, s29, 1
    s_lshr_b32 s64, s52, 1
    s_add_u32 s64, s64, s53
    s_lshl_b32 s64, s64, 8
    s_mul_i32 s54, s51, 7168
    s_add_u32 s64, s64, s54
    s_add_u32 s64, s64, 23068672
    s_add_u32 s52, s52, s53
    s_mul_i32 s53, s51, 28672
    s_lshl_b32 s54, s52, 9
    s_add_u32 s62, s53, s54
    s_add_u32 s62, s62, 8388608
    s_mul_i32 s63, s51, 28672
    s_lshl_b32 s52, s52, 4
    s_add_u32 s63, s63, s52
    s_mov_b32 s44, s4
    s_mov_b32 s45, s5
    s_mov_b32 s46, 1835008
    s_mov_b32 s47, 0x20000
    buffer_load_dwordx4 v[12:15], v25, s[44:47], s63 offen
    s_lshl_b32 s57, s51, 2
    s_add_u32 s57, s57, s58
    s_lshl_b32 s57, s57, 13
    s_add_u32 s57, s57, 6291456
    s_add_u32 s61, s57, 4096
    s_xor_b32 s51, s28, 0
    s_mul_i32 s51, s51, 6144
    s_add_u32 s51, s51, 0
    v_add_u32 v132, s51, v2
    s_xor_b32 s51, s28, 1
    s_mul_i32 s51, s51, 6144
    s_add_u32 s51, s51, 0
    v_add_u32 v133, s51, v2
    s_xor_b32 s51, s28, 4
    s_mul_i32 s51, s51, 6144
    s_add_u32 s51, s51, 2048
    v_add_u32 v134, s51, v2
    s_xor_b32 s51, s28, 5
    s_mul_i32 s51, s51, 6144
    s_add_u32 s51, s51, 4096
    v_add_u32 v135, s51, v2
    s_cmp_lt_u32 s28, 4
    s_cbranch_scc1 P3T_sequential_preLN__softmax_full_mha__glu_gated_reglu__prompt_kernel_41
    s_add_u32 m0, s41, 65536
    s_add_u32 s55, s40, 0
    s_add_u32 s56, s40, 4096
    buffer_load_dwordx4 v2, s[24:27], s55 offen offset:0 sc1 lds
    buffer_load_dwordx4 v2, s[24:27], s55 offen offset:1024 sc1 lds
    buffer_load_dwordx4 v2, s[24:27], s55 offen offset:2048 sc1 lds
    buffer_load_dwordx4 v2, s[24:27], s55 offen offset:3072 sc1 lds
    s_add_u32 m0, s41, 69632
    s_nop 0
    buffer_load_dwordx4 v2, s[24:27], s56 offen offset:0 sc1 lds
    buffer_load_dwordx4 v2, s[24:27], s56 offen offset:1024 sc1 lds
    buffer_load_dwordx4 v2, s[24:27], s56 offen offset:2048 sc1 lds
    s_mov_b32 exec_hi, 0
    buffer_load_dwordx4 v2, s[24:27], s56 offen offset:3072 sc1 lds
    s_mov_b32 exec_hi, -1
    s_add_u32 m0, s41, 96256
    s_add_u32 s55, s40, 30720
    s_add_u32 s56, s40, 34816
    buffer_load_dwordx4 v2, s[24:27], s55 offen offset:0 sc1 lds
    buffer_load_dwordx4 v2, s[24:27], s55 offen offset:1024 sc1 lds
    buffer_load_dwordx4 v2, s[24:27], s55 offen offset:2048 sc1 lds
    buffer_load_dwordx4 v2, s[24:27], s55 offen offset:3072 sc1 lds
    s_add_u32 m0, s41, 100352
    s_nop 0
    buffer_load_dwordx4 v2, s[24:27], s56 offen offset:0 sc1 lds
    buffer_load_dwordx4 v2, s[24:27], s56 offen offset:1024 sc1 lds
    buffer_load_dwordx4 v2, s[24:27], s56 offen offset:2048 sc1 lds
    s_mov_b32 exec_hi, 0
    buffer_load_dwordx4 v2, s[24:27], s56 offen offset:3072 sc1 lds
    s_mov_b32 exec_hi, -1
P3T_sequential_preLN__softmax_full_mha__glu_gated_reglu__prompt_kernel_41:
    s_waitcnt lgkmcnt(0)
    s_cmp_lg_u32 s28, 0
    s_cbranch_scc1 W35_sequential_preLN__softmax_full_mha__glu_gated_reglu__prompt_kernel_42
    s_lshl_b32 s35, s48, 3
    s_add_u32 s35, s35, s49
    s_lshl_b32 s35, s35, 7
    s_add_u32 s35, s35, 23592960
    v_lshlrev_b32 v6, 3, v1
    s_mov_b32 s34, 0
    s_mov_b64 exec, 0xffff
PL_sequential_preLN__softmax_full_mha__glu_gated_reglu__prompt_kernel_43:
    buffer_load_dwordx2 v[8:9], v6, s[24:27], s35 offen sc1
    s_add_u32 s34, s34, 1
    s_cmp_gt_u32 s34, 65536
    s_cbranch_scc1 PL_sequential_preLN__softmax_full_mha__glu_gated_reglu__prompt_kernel_44
    s_waitcnt vmcnt(0)
    v_cmp_ne_u64 vcc, v[8:9], v[4:5]
    s_nop 1
    s_cbranch_vccnz PL_sequential_preLN__softmax_full_mha__glu_gated_reglu__prompt_kernel_43
PL_sequential_preLN__softmax_full_mha__glu_gated_reglu__prompt_kernel_44:
    s_mov_b64 exec, -1
W35_sequential_preLN__softmax_full_mha__glu_gated_reglu__prompt_kernel_42:
    s_barrier
    buffer_load_dwordx4 v[60:63], v2, s[24:27], s57 offen offset:0 sc1
    buffer_load_dwordx4 v[64:67], v2, s[24:27], s57 offen offset:1024 sc1
    buffer_load_dwordx4 v[68:71], v2, s[24:27], s57 offen offset:2048 sc1
    buffer_load_dwordx4 v[72:75], v2, s[24:27], s57 offen offset:3072 sc1
    buffer_load_dwordx4 v[76:79], v2, s[24:27], s61 offen offset:0 sc1
    buffer_load_dwordx4 v[80:83], v2, s[24:27], s61 offen offset:1024 sc1
    buffer_load_dwordx4 v[84:87], v2, s[24:27], s61 offen offset:2048 sc1
    buffer_load_dwordx4 v[88:91], v2, s[24:27], s61 offen offset:3072 sc1
    s_waitcnt vmcnt(7)
    v_mfma_f32_32x32x16_bf16 v[28:43], v[92:95], v[60:63], 0
    v_mfma_f32_32x32x16_bf16 v[44:59], v[96:99], v[60:63], 0
    ds_read_b128 v[92:95], v18 offset:33792
    ds_read_b128 v[96:99], v19 offset:33792
    s_waitcnt vmcnt(6)
    v_mfma_f32_32x32x16_bf16 v[28:43], v[100:103], v[64:67], v[28:43]
    v_mfma_f32_32x32x16_bf16 v[44:59], v[104:107], v[64:67], v[44:59]
    ds_read_b128 v[100:103], v18 offset:34816
    ds_read_b128 v[104:107], v19 offset:34816
    s_waitcnt vmcnt(5)
    v_mfma_f32_32x32x16_bf16 v[28:43], v[108:111], v[68:71], v[28:43]
    v_mfma_f32_32x32x16_bf16 v[44:59], v[112:115], v[68:71], v[44:59]
    ds_read_b128 v[108:111], v18 offset:35840
    ds_read_b128 v[112:115], v19 offset:35840
    s_waitcnt vmcnt(4)
    v_mfma_f32_32x32x16_bf16 v[28:43], v[116:119], v[72:75], v[28:43]
    v_mfma_f32_32x32x16_bf16 v[44:59], v[120:123], v[72:75], v[44:59]
    s_waitcnt vmcnt(3)
    v_mfma_f32_32x32x16_bf16 v[28:43], v[124:127], v[76:79], v[28:43]
    v_mfma_f32_32x32x16_bf16 v[44:59], v[128:131], v[76:79], v[44:59]
    s_waitcnt vmcnt(2)
    s_waitcnt lgkmcnt(4)
    v_mfma_f32_32x32x16_bf16 v[28:43], v[92:95], v[80:83], v[28:43]
    v_mfma_f32_32x32x16_bf16 v[44:59], v[96:99], v[80:83], v[44:59]
    s_waitcnt vmcnt(1)
    s_waitcnt lgkmcnt(2)
    v_mfma_f32_32x32x16_bf16 v[28:43], v[100:103], v[84:87], v[28:43]
    v_mfma_f32_32x32x16_bf16 v[44:59], v[104:107], v[84:87], v[44:59]
    s_waitcnt vmcnt(0)
    s_waitcnt lgkmcnt(0)
    v_mfma_f32_32x32x16_bf16 v[28:43], v[108:111], v[88:91], v[28:43]
    v_mfma_f32_32x32x16_bf16 v[44:59], v[112:115], v[88:91], v[44:59]
    s_barrier
    v_lshlrev_b32 v84, 16, v12
    v_and_b32 v85, 0xffff0000, v12
    v_lshlrev_b32 v86, 16, v13
    v_and_b32 v87, 0xffff0000, v13
    v_lshlrev_b32 v88, 16, v14
    v_and_b32 v89, 0xffff0000, v14
    v_lshlrev_b32 v90, 16, v15
    v_and_b32 v91, 0xffff0000, v15
    s_nop 2
    ds_write_b128 v133, v[36:39]
    ds_write_b128 v133, v[40:43] offset:1024
    ds_write_b128 v134, v[44:47]
    ds_write_b128 v134, v[48:51] offset:1024
    ds_write_b128 v135, v[52:55]
    ds_write_b128 v135, v[56:59] offset:1024
    v_add_f32 v28, v28, v84
    v_add_f32 v29, v29, v85
    v_add_f32 v30, v30, v86
    v_add_f32 v31, v31, v87
    v_add_f32 v32, v32, v88
    v_add_f32 v33, v33, v89
    v_add_f32 v34, v34, v90
    v_add_f32 v35, v35, v91
    v_mov_b32 v136, 0
    v_mov_b32 v137, 0
    s_mov_b32 s51, 0x3f803f80
    v_lshlrev_b32 v23, 3, v1
    s_waitcnt lgkmcnt(0)
    s_barrier
    ds_read_b128 v[60:63], v132 offset:0
    ds_read_b128 v[64:67], v132 offset:1024
    ds_read_b128 v[68:71], v132 offset:2048
    ds_read_b128 v[72:75], v132 offset:3072
    ds_read_b128 v[76:79], v132 offset:4096
    ds_read_b128 v[80:83], v132 offset:5120
    s_waitcnt lgkmcnt(4)
    v_add_f32 v28, v28, v60
    v_add_f32 v29, v29, v61
    v_add_f32 v30, v30, v62
    v_add_f32 v31, v31, v63
    v_add_f32 v32, v32, v64
    v_add_f32 v33, v33, v65
    v_add_f32 v34, v34, v66
    v_add_f32 v35, v35, v67
    s_waitcnt lgkmcnt(2)
    v_add_f32 v28, v28, v68
    v_add_f32 v29, v29, v69
    v_add_f32 v30, v30, v70
    v_add_f32 v31, v31, v71
    v_add_f32 v32, v32, v72
    v_add_f32 v33, v33, v73
    v_add_f32 v34, v34, v74
    v_add_f32 v35, v35, v75
    s_waitcnt lgkmcnt(0)
    v_add_f32 v28, v28, v76
    v_add_f32 v29, v29, v77
    v_add_f32 v30, v30, v78
    v_add_f32 v31, v31, v79
    v_add_f32 v32, v32, v80
    v_add_f32 v33, v33, v81
    v_add_f32 v34, v34, v82
    v_add_f32 v35, v35, v83
    v_cvt_pk_bf16_f32 v12, v28, v29
    v_cvt_pk_bf16_f32 v13, v30, v31
    v_cvt_pk_bf16_f32 v14, v32, v33
    v_cvt_pk_bf16_f32 v15, v34, v35
    buffer_store_dwordx4 v[12:15], v24, s[24:27], s62 offen sc1
    v_dot2c_f32_bf16 v136, s51, v12
    v_dot2c_f32_bf16 v137, v12, v12
    v_dot2c_f32_bf16 v136, s51, v13
    v_dot2c_f32_bf16 v137, v13, v13
    v_dot2c_f32_bf16 v136, s51, v14
    v_dot2c_f32_bf16 v137, v14, v14
    v_dot2c_f32_bf16 v136, s51, v15
    v_dot2c_f32_bf16 v137, v15, v15
    s_nop 2
    v_mov_b32 v22, v136
    s_nop 1
    v_permlane32_swap_b32 v136, v22
    v_add_f32 v136, v136, v22
    v_mov_b32 v22, v137
    s_nop 1
    v_permlane32_swap_b32 v137, v22
    v_add_f32 v137, v137, v22
    s_mov_b32 exec_hi, 0
    buffer_store_dwordx2 v[136:137], v23, s[24:27], s64 offen sc1
    s_mov_b32 exec_hi, -1
    s_branch P35E_sequential_preLN__softmax_full_mha__glu_gated_reglu__prompt_kernel_40
P35X_sequential_preLN__softmax_full_mha__glu_gated_reglu__prompt_kernel_39:
    s_cmp_lt_u32 s28, 4
    s_cbranch_scc1 P3T_sequential_preLN__softmax_full_mha__glu_gated_reglu__prompt_kernel_45
    s_add_u32 m0, s41, 65536
    s_add_u32 s55, s40, 0
    s_add_u32 s56, s40, 4096
    buffer_load_dwordx4 v2, s[24:27], s55 offen offset:0 sc1 lds
    buffer_load_dwordx4 v2, s[24:27], s55 offen offset:1024 sc1 lds
    buffer_load_dwordx4 v2, s[24:27], s55 offen offset:2048 sc1 lds
    buffer_load_dwordx4 v2, s[24:27], s55 offen offset:3072 sc1 lds
    s_add_u32 m0, s41, 69632
    s_nop 0
    buffer_load_dwordx4 v2, s[24:27], s56 offen offset:0 sc1 lds
    buffer_load_dwordx4 v2, s[24:27], s56 offen offset:1024 sc1 lds
    buffer_load_dwordx4 v2, s[24:27], s56 offen offset:2048 sc1 lds
    s_mov_b32 exec_hi, 0
    buffer_load_dwordx4 v2, s[24:27], s56 offen offset:3072 sc1 lds
    s_mov_b32 exec_hi, -1
    s_add_u32 m0, s41, 96256
    s_add_u32 s55, s40, 30720
    s_add_u32 s56, s40, 34816
    buffer_load_dwordx4 v2, s[24:27], s55 offen offset:0 sc1 lds
    buffer_load_dwordx4 v2, s[24:27], s55 offen offset:1024 sc1 lds
    buffer_load_dwordx4 v2, s[24:27], s55 offen offset:2048 sc1 lds
    buffer_load_dwordx4 v2, s[24:27], s55 offen offset:3072 sc1 lds
    s_add_u32 m0, s41, 100352
    s_nop 0
    buffer_load_dwordx4 v2, s[24:27], s56 offen offset:0 sc1 lds
    buffer_load_dwordx4 v2, s[24:27], s56 offen offset:1024 sc1 lds
    buffer_load_dwordx4 v2, s[24:27], s56 offen offset:2048 sc1 lds
    s_mov_b32 exec_hi, 0
    buffer_load_dwordx4 v2, s[24:27], s56 offen offset:3072 sc1 lds
    s_mov_b32 exec_hi, -1
P3T_sequential_preLN__softmax_full_mha__glu_gated_reglu__prompt_kernel_45:
    s_bfe_u32 s51, s2, 0x20003
    s_lshl_b32 s51, s51, 3
    s_add_u32 s51, s51, s28
    s_mul_i32 s53, s51, 960
    s_bfe_u32 s52, s2, 0x20001
    s_mul_i32 s52, s52, 860160
    s_add_u32 s53, s53, s52
    v_lshrrev_b32 v22, 3, v1
    v_mul_u32_u24 v22, 215040, v22
    v_and_b32 v23, 7, v1
    v_lshl_add_u32 v22, v23, 7, v22
    s_mov_b32 exec_hi, 0
    s_add_u32 s52, s53, 19689472
    buffer_load_dword v23, v22, s[24:27], s52 offen sc1
    s_add_u32 s52, s53, 19720192
    buffer_load_dword v23, v22, s[24:27], s52 offen sc1
    s_add_u32 s52, s53, 19750912
    buffer_load_dword v23, v22, s[24:27], s52 offen sc1
    s_add_u32 s52, s53, 19781632
    buffer_load_dword v23, v22, s[24:27], s52 offen sc1
    s_add_u32 s52, s53, 19812352
    buffer_load_dword v23, v22, s[24:27], s52 offen sc1
    s_mov_b32 exec_hi, -1
P35E_sequential_preLN__softmax_full_mha__glu_gated_reglu__prompt_kernel_40:
    s_and_b32 s35, s2, 7
    s_lshl_b32 s35, s35, 1
    s_bfe_u32 s34, s2, 0x10004
    s_add_u32 s35, s35, s34
    s_and_b32 s36, s2, 8
    s_lshr_b32 s34, s2, 5
    s_add_u32 s36, s36, s34
    s_lshl_b32 s37, s35, 8
    s_add_u32 s37, s37, s36
    s_lshl_b32 s37, s37, 3
    s_add_u32 s37, s37, 23625728
    v_lshlrev_b32 v8, 7, v1
    s_waitcnt vmcnt(0)
    s_barrier
    s_cmp_lg_u32 s28, 0
    s_cbranch_scc1 SG_sequential_preLN__softmax_full_mha__glu_gated_reglu__prompt_kernel_46
    s_mov_b64 exec, 0xffff
    buffer_store_dwordx2 v[4:5], v8, s[24:27], s37 offen sc1
    s_mov_b64 exec, -1
SG_sequential_preLN__softmax_full_mha__glu_gated_reglu__prompt_kernel_46:
    s_lshl_b32 s42, s38, 2
    s_add_u32 s42, s42, s29
    s_mul_i32 s43, s29, 768
    s_add_u32 s43, s43, 157696
    v_lshlrev_b32 v16, 2, v1
    v_add_u32 v16, s43, v16
    s_cmp_lt_u32 s28, 4
    s_cbranch_scc1 P4C_sequential_preLN__softmax_full_mha__glu_gated_reglu__prompt_kernel_47
    s_add_u32 m0, s41, 126976
    s_add_u32 s47, s40, 61440
    s_add_u32 s48, s40, 65536
    buffer_load_dwordx4 v2, s[24:27], s47 offen offset:0 sc1 lds
    buffer_load_dwordx4 v2, s[24:27], s47 offen offset:1024 sc1 lds
    buffer_load_dwordx4 v2, s[24:27], s47 offen offset:2048 sc1 lds
    buffer_load_dwordx4 v2, s[24:27], s47 offen offset:3072 sc1 lds
    s_add_u32 m0, s41, 131072
    s_nop 0
    buffer_load_dwordx4 v2, s[24:27], s48 offen offset:0 sc1 lds
    buffer_load_dwordx4 v2, s[24:27], s48 offen offset:1024 sc1 lds
    buffer_load_dwordx4 v2, s[24:27], s48 offen offset:2048 sc1 lds
    s_mov_b32 exec_hi, 0
    buffer_load_dwordx4 v2, s[24:27], s48 offen offset:3072 sc1 lds
    s_mov_b32 exec_hi, -1
    s_add_u32 m0, s41, 0
    s_add_u32 s47, s40, 92160
    s_add_u32 s48, s40, 96256
    buffer_load_dwordx4 v2, s[24:27], s47 offen offset:0 sc1 lds
    buffer_load_dwordx4 v2, s[24:27], s47 offen offset:1024 sc1 lds
    buffer_load_dwordx4 v2, s[24:27], s47 offen offset:2048 sc1 lds
    buffer_load_dwordx4 v2, s[24:27], s47 offen offset:3072 sc1 lds
    s_add_u32 m0, s41, 4096
    s_nop 0
    buffer_load_dwordx4 v2, s[24:27], s48 offen offset:0 sc1 lds
    buffer_load_dwordx4 v2, s[24:27], s48 offen offset:1024 sc1 lds
    buffer_load_dwordx4 v2, s[24:27], s48 offen offset:2048 sc1 lds
    s_mov_b32 exec_hi, 0
    buffer_load_dwordx4 v2, s[24:27], s48 offen offset:3072 sc1 lds
    s_mov_b32 exec_hi, -1
    s_mul_i32 s49, s42, 7168
    s_add_u32 s49, s49, 23068672
    v_lshrrev_b32 v17, 5, v1
    v_mul_u32_u24 v17, 3584, v17
    v_and_b32 v48, 31, v1
    v_lshl_add_u32 v17, v48, 3, v17
    s_lshr_b32 s43, s2, 5
    s_min_u32 s43, s43, 6
    s_mul_i32 s50, s43, 229376
    s_mul_i32 s51, s29, 7168
    s_add_u32 s50, s50, s51
    s_add_u32 s50, s50, 18022400
    s_waitcnt vmcnt(8)
    s_barrier
    buffer_load_dwordx2 v[20:21], v17, s[24:27], s49 offen offset:0 sc1
    buffer_load_dwordx2 v[22:23], v17, s[24:27], s49 offen offset:256 sc1
    buffer_load_dwordx2 v[24:25], v17, s[24:27], s49 offen offset:512 sc1
    buffer_load_dwordx2 v[26:27], v17, s[24:27], s49 offen offset:768 sc1
    buffer_load_dwordx2 v[28:29], v17, s[24:27], s49 offen offset:1024 sc1
    buffer_load_dwordx2 v[30:31], v17, s[24:27], s49 offen offset:1280 sc1
    buffer_load_dwordx2 v[32:33], v17, s[24:27], s49 offen offset:1536 sc1
    buffer_load_dwordx2 v[34:35], v17, s[24:27], s49 offen offset:1792 sc1
    buffer_load_dwordx2 v[36:37], v17, s[24:27], s49 offen offset:2048 sc1
    buffer_load_dwordx2 v[38:39], v17, s[24:27], s49 offen offset:2304 sc1
    buffer_load_dwordx2 v[40:41], v17, s[24:27], s49 offen offset:2560 sc1
    buffer_load_dwordx2 v[42:43], v17, s[24:27], s49 offen offset:2816 sc1
    buffer_load_dwordx2 v[44:45], v17, s[24:27], s49 offen offset:3072 sc1
    buffer_load_dwordx2 v[46:47], v17, s[24:27], s49 offen offset:3328 sc1
    s_add_u32 m0, s41, 30720
    s_add_u32 s47, s40, 122880
    s_add_u32 s48, s40, 126976
    buffer_load_dwordx4 v2, s[24:27], s47 offen offset:0 sc1 lds
    buffer_load_dwordx4 v2, s[24:27], s47 offen offset:1024 sc1 lds
    buffer_load_dwordx4 v2, s[24:27], s47 offen offset:2048 sc1 lds
    buffer_load_dwordx4 v2, s[24:27], s47 offen offset:3072 sc1 lds
    s_add_u32 m0, s41, 34816
    s_nop 0
    buffer_load_dwordx4 v2, s[24:27], s48 offen offset:0 sc1 lds
    buffer_load_dwordx4 v2, s[24:27], s48 offen offset:1024 sc1 lds
    buffer_load_dwordx4 v2, s[24:27], s48 offen offset:2048 sc1 lds
    s_mov_b32 exec_hi, 0
    buffer_load_dwordx4 v2, s[24:27], s48 offen offset:3072 sc1 lds
    s_mov_b32 exec_hi, -1
    s_waitcnt vmcnt(8)
    v_add_f32 v20, v20, v22
    v_add_f32 v21, v21, v23
    v_add_f32 v20, v20, v24
    v_add_f32 v21, v21, v25
    v_add_f32 v20, v20, v26
    v_add_f32 v21, v21, v27
    v_add_f32 v20, v20, v28
    v_add_f32 v21, v21, v29
    v_add_f32 v20, v20, v30
    v_add_f32 v21, v21, v31
    v_add_f32 v20, v20, v32
    v_add_f32 v21, v21, v33
    v_add_f32 v20, v20, v34
    v_add_f32 v21, v21, v35
    v_add_f32 v20, v20, v36
    v_add_f32 v21, v21, v37
    v_add_f32 v20, v20, v38
    v_add_f32 v21, v21, v39
    v_add_f32 v20, v20, v40
    v_add_f32 v21, v21, v41
    v_add_f32 v20, v20, v42
    v_add_f32 v21, v21, v43
    v_add_f32 v20, v20, v44
    v_add_f32 v21, v21, v45
    v_add_f32 v20, v20, v46
    v_add_f32 v21, v21, v47
    v_mov_b32 v48, v20
    s_nop 1
    v_permlane32_swap_b32 v20, v48
    v_add_f32 v20, v20, v48
    v_mov_b32 v48, v21
    s_nop 1
    v_permlane32_swap_b32 v21, v48
    v_add_f32 v21, v21, v48
    v_mul_f32 v20, 0xbb124925, v20
    v_mul_f32 v21, 0x3b124925, v21
    v_fma_f32 v48, -v20, v20, v21
    v_max_f32 v48, 0, v48
    v_add_f32 v48, 0x3727c5ac, v48
    v_rsq_f32 v56, v48
    v_cvt_pk_bf16_f32 v52, v20, v20
    v_lshlrev_b32 v49, 16, v52
    v_sub_f32 v49, v20, v49
    v_mov_b32 v54, 0
    v_cvt_pk_bf16_f32 v53, v49, v54
    v_mov_b32 v55, 0
    v_mul_f32 v56, v56, v56
    ds_write_b32 v16, v52
    ds_write_b32 v16, v53 offset:256
    ds_write_b32 v16, v56 offset:512
    s_waitcnt lgkmcnt(0)
    s_barrier
    s_waitcnt vmcnt(0)
    s_barrier
    s_add_u32 m0, s41, 65536
    s_add_u32 s47, s40, 153600
    s_add_u32 s48, s40, 157696
    buffer_load_dwordx4 v2, s[24:27], s47 offen offset:0 sc1 lds
    buffer_load_dwordx4 v2, s[24:27], s47 offen offset:1024 sc1 lds
    buffer_load_dwordx4 v2, s[24:27], s47 offen offset:2048 sc1 lds
    buffer_load_dwordx4 v2, s[24:27], s47 offen offset:3072 sc1 lds
    s_add_u32 m0, s41, 69632
    s_nop 0
    buffer_load_dwordx4 v2, s[24:27], s48 offen offset:0 sc1 lds
    buffer_load_dwordx4 v2, s[24:27], s48 offen offset:1024 sc1 lds
    buffer_load_dwordx4 v2, s[24:27], s48 offen offset:2048 sc1 lds
    s_mov_b32 exec_hi, 0
    buffer_load_dwordx4 v2, s[24:27], s48 offen offset:3072 sc1 lds
    s_mov_b32 exec_hi, -1
    s_add_u32 m0, s41, 96256
    s_add_u32 s47, s40, 184320
    s_add_u32 s48, s40, 188416
    buffer_load_dwordx4 v2, s[24:27], s47 offen offset:0 sc1 lds
    buffer_load_dwordx4 v2, s[24:27], s47 offen offset:1024 sc1 lds
    buffer_load_dwordx4 v2, s[24:27], s47 offen offset:2048 sc1 lds
    buffer_load_dwordx4 v2, s[24:27], s47 offen offset:3072 sc1 lds
    s_add_u32 m0, s41, 100352
    s_nop 0
    buffer_load_dwordx4 v2, s[24:27], s48 offen offset:0 sc1 lds
    buffer_load_dwordx4 v2, s[24:27], s48 offen offset:1024 sc1 lds
    buffer_load_dwordx4 v2, s[24:27], s48 offen offset:2048 sc1 lds
    s_mov_b32 exec_hi, 0
    buffer_load_dwordx4 v2, s[24:27], s48 offen offset:3072 sc1 lds
    s_mov_b32 exec_hi, -1
    s_add_u32 m0, s51, 126976
    s_add_u32 s47, s50, 0
    s_add_u32 s48, s50, 4096
    buffer_load_dwordx4 v2, s[24:27], s47 offen offset:0 sc1 lds
    buffer_load_dwordx4 v2, s[24:27], s47 offen offset:1024 sc1 lds
    buffer_load_dwordx4 v2, s[24:27], s47 offen offset:2048 sc1 lds
    buffer_load_dwordx4 v2, s[24:27], s47 offen offset:3072 sc1 lds
    s_add_u32 m0, s51, 131072
    s_nop 0
    buffer_load_dwordx4 v2, s[24:27], s48 offen offset:0 sc1 lds
    buffer_load_dwordx4 v2, s[24:27], s48 offen offset:1024 sc1 lds
    buffer_load_dwordx4 v2, s[24:27], s48 offen offset:2048 sc1 lds
    s_waitcnt vmcnt(7)
    s_barrier
    s_add_u32 m0, s51, 0
    s_add_u32 s47, s50, 28672
    s_add_u32 s48, s50, 32768
    buffer_load_dwordx4 v2, s[24:27], s47 offen offset:0 sc1 lds
    buffer_load_dwordx4 v2, s[24:27], s47 offen offset:1024 sc1 lds
    buffer_load_dwordx4 v2, s[24:27], s47 offen offset:2048 sc1 lds
    buffer_load_dwordx4 v2, s[24:27], s47 offen offset:3072 sc1 lds
    s_add_u32 m0, s51, 4096
    s_nop 0
    buffer_load_dwordx4 v2, s[24:27], s48 offen offset:0 sc1 lds
    buffer_load_dwordx4 v2, s[24:27], s48 offen offset:1024 sc1 lds
    buffer_load_dwordx4 v2, s[24:27], s48 offen offset:2048 sc1 lds
    s_add_u32 m0, s51, 30720
    s_add_u32 s47, s50, 57344
    s_add_u32 s48, s50, 61440
    buffer_load_dwordx4 v2, s[24:27], s47 offen offset:0 sc1 lds
    buffer_load_dwordx4 v2, s[24:27], s47 offen offset:1024 sc1 lds
    buffer_load_dwordx4 v2, s[24:27], s47 offen offset:2048 sc1 lds
    buffer_load_dwordx4 v2, s[24:27], s47 offen offset:3072 sc1 lds
    s_add_u32 m0, s51, 34816
    s_nop 0
    buffer_load_dwordx4 v2, s[24:27], s48 offen offset:0 sc1 lds
    buffer_load_dwordx4 v2, s[24:27], s48 offen offset:1024 sc1 lds
    buffer_load_dwordx4 v2, s[24:27], s48 offen offset:2048 sc1 lds
    s_waitcnt vmcnt(0)
    s_branch P4J_sequential_preLN__softmax_full_mha__glu_gated_reglu__prompt_kernel_48
P4C_sequential_preLN__softmax_full_mha__glu_gated_reglu__prompt_kernel_47:
    s_mul_i32 s49, s42, 28672
    s_add_u32 s49, s49, 8388608
    s_add_u32 s50, s49, 4096
    s_add_u32 s51, s49, 8192
    s_add_u32 s52, s49, 12288
    s_add_u32 s53, s49, 16384
    s_add_u32 s54, s49, 20480
    s_add_u32 s55, s49, 24576
    s_mul_i32 s56, s42, 114688
    s_mul_i32 s44, s39, 7168
    s_add_u32 s56, s56, s44
    s_add_u32 s56, s56, 10223616
    s_add_u32 s57, s56, 4096
    v_add_u32 v17, 65536, v2
    v_add_u32 v18, 126976, v2
    v_add_u32 v19, 0, v2
    v_lshrrev_b32 v253, 5, v1
    v_mul_u32_u24 v253, 768, v253
    v_lshl_add_u32 v253, v1, 2, v253
    v_add_u32 v20, 94208, v253
    v_add_u32 v21, 155648, v253
    v_add_u32 v22, 28672, v253
    v_mov_b32 v246, 0
    v_mov_b32 v250, 0
    v_mov_b32 v247, 0
    v_mov_b32 v251, 0
    s_cmp_lg_u32 s28, 0
    s_cbranch_scc1 W4_sequential_preLN__softmax_full_mha__glu_gated_reglu__prompt_kernel_49
    s_lshl_b32 s35, s38, 4
    s_add_u32 s35, s35, s39
    s_lshl_b32 s35, s35, 7
    s_add_u32 s35, s35, 23625728
    v_lshlrev_b32 v6, 3, v1
    s_mov_b32 s34, 0
    s_mov_b64 exec, 0x7f7f
PL_sequential_preLN__softmax_full_mha__glu_gated_reglu__prompt_kernel_50:
    buffer_load_dwordx2 v[8:9], v6, s[24:27], s35 offen sc1
    s_add_u32 s34, s34, 1
    s_cmp_gt_u32 s34, 65536
    s_cbranch_scc1 PL_sequential_preLN__softmax_full_mha__glu_gated_reglu__prompt_kernel_51
    s_waitcnt vmcnt(0)
    v_cmp_ne_u64 vcc, v[8:9], v[4:5]
    s_nop 1
    s_cbranch_vccnz PL_sequential_preLN__softmax_full_mha__glu_gated_reglu__prompt_kernel_50
PL_sequential_preLN__softmax_full_mha__glu_gated_reglu__prompt_kernel_51:
    s_mov_b64 exec, -1
W4_sequential_preLN__softmax_full_mha__glu_gated_reglu__prompt_kernel_49:
    s_barrier
    buffer_load_dwordx4 v[24:27], v2, s[24:27], s49 offen offset:0 sc1
    buffer_load_dwordx4 v[28:31], v2, s[24:27], s49 offen offset:1024 sc1
    buffer_load_dwordx4 v[32:35], v2, s[24:27], s49 offen offset:2048 sc1
    buffer_load_dwordx4 v[36:39], v2, s[24:27], s49 offen offset:3072 sc1
    buffer_load_dwordx4 v[40:43], v2, s[24:27], s50 offen offset:0 sc1
    buffer_load_dwordx4 v[44:47], v2, s[24:27], s50 offen offset:1024 sc1
    buffer_load_dwordx4 v[48:51], v2, s[24:27], s50 offen offset:2048 sc1
    buffer_load_dwordx4 v[52:55], v2, s[24:27], s50 offen offset:3072 sc1
    ds_read_b128 v[200:203], v17 offset:0
    ds_read_b128 v[204:207], v17 offset:30720
    ds_read_b128 v[208:211], v18 offset:0
    ds_read_b128 v[212:215], v17 offset:1024
    ds_read_b128 v[216:219], v17 offset:31744
    ds_read_b128 v[220:223], v18 offset:1024
    ds_read_b128 v[224:227], v17 offset:2048
    s_waitcnt vmcnt(7)
    s_waitcnt lgkmcnt(5)
    v_mfma_f32_32x32x16_bf16 v[136:151], v[200:203], v[24:27], 0
    ds_read_b128 v[228:231], v17 offset:32768
    v_mfma_f32_32x32x16_bf16 v[152:167], v[204:207], v[24:27], 0
    ds_read_b128 v[200:203], v18 offset:2048
    buffer_load_dwordx4 v[56:59], v2, s[24:27], s51 offen offset:0 sc1
    s_waitcnt lgkmcnt(5)
    v_mfma_f32_32x32x16_bf16 v[168:183], v[208:211], v[24:27], 0
    ds_read_b128 v[204:207], v17 offset:3072
    s_waitcnt vmcnt(7)
    v_mfma_f32_32x32x16_bf16 v[136:151], v[212:215], v[28:31], v[136:151]
    ds_read_b128 v[208:211], v17 offset:33792
    s_waitcnt lgkmcnt(5)
    v_mfma_f32_32x32x16_bf16 v[152:167], v[216:219], v[28:31], v[152:167]
    ds_read_b128 v[212:215], v18 offset:3072
    buffer_load_dwordx4 v[60:63], v2, s[24:27], s51 offen offset:1024 sc1
    v_mfma_f32_32x32x16_bf16 v[168:183], v[220:223], v[28:31], v[168:183]
    ds_read_b128 v[216:219], v17 offset:4096
    s_waitcnt vmcnt(7)
    s_waitcnt lgkmcnt(5)
    v_mfma_f32_32x32x16_bf16 v[136:151], v[224:227], v[32:35], v[136:151]
    ds_read_b128 v[220:223], v17 offset:34816
    v_mfma_f32_32x32x16_bf16 v[152:167], v[228:231], v[32:35], v[152:167]
    ds_read_b128 v[224:227], v18 offset:4096
    buffer_load_dwordx4 v[64:67], v2, s[24:27], s51 offen offset:2048 sc1
    s_waitcnt lgkmcnt(5)
    v_mfma_f32_32x32x16_bf16 v[168:183], v[200:203], v[32:35], v[168:183]
    ds_read_b128 v[228:231], v17 offset:5120
    s_waitcnt vmcnt(7)
    v_mfma_f32_32x32x16_bf16 v[136:151], v[204:207], v[36:39], v[136:151]
    ds_read_b128 v[200:203], v17 offset:35840
    s_waitcnt lgkmcnt(5)
    v_mfma_f32_32x32x16_bf16 v[152:167], v[208:211], v[36:39], v[152:167]
    ds_read_b128 v[204:207], v18 offset:5120
    buffer_load_dwordx4 v[68:71], v2, s[24:27], s51 offen offset:3072 sc1
    v_mfma_f32_32x32x16_bf16 v[168:183], v[212:215], v[36:39], v[168:183]
    ds_read_b128 v[208:211], v17 offset:6144
    s_waitcnt vmcnt(7)
    s_waitcnt lgkmcnt(5)
    v_mfma_f32_32x32x16_bf16 v[136:151], v[216:219], v[40:43], v[136:151]
    ds_read_b128 v[212:215], v17 offset:36864
    ds_read_b32 v232, v20 offset:0
    ds_read_b32 v233, v20 offset:128
    ds_read_b32 v234, v20 offset:256
    v_mfma_f32_32x32x16_bf16 v[152:167], v[220:223], v[40:43], v[152:167]
    ds_read_b128 v[216:219], v18 offset:6144
    buffer_load_dwordx4 v[72:75], v2, s[24:27], s52 offen offset:0 sc1
    ds_read_b32 v235, v20 offset:384
    ds_read_b32 v236, v20 offset:512
    ds_read_b32 v237, v20 offset:640
    s_waitcnt lgkmcnt(11)
    v_mfma_f32_32x32x16_bf16 v[168:183], v[224:227], v[40:43], v[168:183]
    ds_read_b128 v[220:223], v17 offset:7168
    ds_read_b32 v238, v20 offset:768
    s_waitcnt vmcnt(7)
    v_mfma_f32_32x32x16_bf16 v[136:151], v[228:231], v[44:47], v[136:151]
    ds_read_b128 v[224:227], v17 offset:37888
    s_waitcnt lgkmcnt(12)
    v_mfma_f32_32x32x16_bf16 v[152:167], v[200:203], v[44:47], v[152:167]
    ds_read_b128 v[228:231], v18 offset:7168
    buffer_load_dwordx4 v[76:79], v2, s[24:27], s52 offen offset:1024 sc1
    v_mfma_f32_32x32x16_bf16 v[168:183], v[204:207], v[44:47], v[168:183]
    ds_read_b128 v[200:203], v17 offset:8192
    s_waitcnt vmcnt(7)
    s_waitcnt lgkmcnt(12)
    v_mfma_f32_32x32x16_bf16 v[136:151], v[208:211], v[48:51], v[136:151]
    ds_read_b128 v[204:207], v17 offset:38912
    s_waitcnt lgkmcnt(4)
    v_add_f32 v232, v232, v233
    v_add_f32 v234, v234, v235
    v_add_f32 v236, v236, v237
    v_mfma_f32_32x32x16_bf16 v[152:167], v[212:215], v[48:51], v[152:167]
    ds_read_b128 v[208:211], v18 offset:8192
    buffer_load_dwordx4 v[80:83], v2, s[24:27], s52 offen offset:2048 sc1
    v_add_f32 v232, v232, v234
    v_add_f32 v236, v236, v238
    v_add_f32 v232, v232, v236
    v_cvt_pk_bf16_f32 v241, v232, v232
    v_mfma_f32_32x32x16_bf16 v[168:183], v[216:219], v[48:51], v[168:183]
    ds_read_b128 v[212:215], v17 offset:9216
    v_lshlrev_b32 v253, 16, v241
    v_sub_f32 v232, v232, v253
    v_cvt_pk_bf16_f32 v240, v253, v232
    s_waitcnt vmcnt(7)
    v_mfma_f32_32x32x16_bf16 v[136:151], v[220:223], v[52:55], v[136:151]
    ds_read_b128 v[216:219], v17 offset:39936
    s_waitcnt lgkmcnt(5)
    v_mfma_f32_32x32x16_bf16 v[152:167], v[224:227], v[52:55], v[152:167]
    ds_read_b128 v[220:223], v18 offset:9216
    buffer_load_dwordx4 v[84:87], v2, s[24:27], s52 offen offset:3072 sc1
    ds_read_b32 v232, v20 offset:30720
    ds_read_b32 v233, v20 offset:30848
    ds_read_b32 v234, v20 offset:30976
    v_mfma_f32_32x32x16_bf16 v[168:183], v[228:231], v[52:55], v[168:183]
    ds_read_b128 v[224:227], v17 offset:10240
    ds_read_b32 v235, v20 offset:31104
    ds_read_b32 v236, v20 offset:31232
    ds_read_b32 v237, v20 offset:31360
    s_waitcnt vmcnt(7)
    s_waitcnt lgkmcnt(11)
    v_mfma_f32_32x32x16_bf16 v[136:151], v[200:203], v[56:59], v[136:151]
    ds_read_b128 v[228:231], v17 offset:40960
    ds_read_b32 v238, v20 offset:31488
    v_mfma_f32_32x32x16_bf16 v[152:167], v[204:207], v[56:59], v[152:167]
    ds_read_b128 v[200:203], v18 offset:10240
    buffer_load_dwordx4 v[88:91], v2, s[24:27], s53 offen offset:0 sc1
    s_waitcnt lgkmcnt(12)
    v_mfma_f32_32x32x16_bf16 v[168:183], v[208:211], v[56:59], v[168:183]
    ds_read_b128 v[204:207], v17 offset:11264
    s_waitcnt vmcnt(7)
    v_mfma_f32_32x32x16_bf16 v[136:151], v[212:215], v[60:63], v[136:151]
    ds_read_b128 v[208:211], v17 offset:41984
    s_waitcnt lgkmcnt(12)
    v_mfma_f32_32x32x16_bf16 v[152:167], v[216:219], v[60:63], v[152:167]
    ds_read_b128 v[212:215], v18 offset:11264
    buffer_load_dwordx4 v[92:95], v2, s[24:27], s53 offen offset:1024 sc1
    s_waitcnt lgkmcnt(4)
    v_add_f32 v232, v232, v233
    v_add_f32 v234, v234, v235
    v_add_f32 v236, v236, v237
    v_mfma_f32_32x32x16_bf16 v[168:183], v[220:223], v[60:63], v[168:183]
    ds_read_b128 v[216:219], v17 offset:12288
    v_add_f32 v232, v232, v234
    v_add_f32 v236, v236, v238
    v_add_f32 v232, v232, v236
    v_cvt_pk_bf16_f32 v243, v232, v232
    s_waitcnt vmcnt(7)
    v_mfma_f32_32x32x16_bf16 v[136:151], v[224:227], v[64:67], v[136:151]
    ds_read_b128 v[220:223], v17 offset:43008
    v_lshlrev_b32 v253, 16, v243
    v_sub_f32 v232, v232, v253
    v_cvt_pk_bf16_f32 v242, v253, v232
    v_mfma_f32_32x32x16_bf16 v[152:167], v[228:231], v[64:67], v[152:167]
    ds_read_b128 v[224:227], v18 offset:12288
    buffer_load_dwordx4 v[96:99], v2, s[24:27], s53 offen offset:2048 sc1
    s_waitcnt lgkmcnt(5)
    v_mfma_f32_32x32x16_bf16 v[168:183], v[200:203], v[64:67], v[168:183]
    ds_read_b128 v[228:231], v17 offset:13312
    ds_read_b32 v232, v21 offset:0
    ds_read_b32 v233, v21 offset:128
    ds_read_b32 v234, v21 offset:256
    s_waitcnt vmcnt(7)
    v_mfma_f32_32x32x16_bf16 v[136:151], v[204:207], v[68:71], v[136:151]
    ds_read_b128 v[200:203], v17 offset:44032
    ds_read_b32 v235, v21 offset:384
    ds_read_b32 v236, v21 offset:512
    ds_read_b32 v237, v21 offset:640
    s_waitcnt lgkmcnt(11)
    v_mfma_f32_32x32x16_bf16 v[152:167], v[208:211], v[68:71], v[152:167]
    ds_read_b128 v[204:207], v18 offset:13312
    buffer_load_dwordx4 v[100:103], v2, s[24:27], s53 offen offset:3072 sc1
    ds_read_b32 v238, v21 offset:768
    v_mfma_f32_32x32x16_bf16 v[168:183], v[212:215], v[68:71], v[168:183]
    ds_read_b128 v[208:211], v17 offset:14336
    s_waitcnt vmcnt(7)
    s_waitcnt lgkmcnt(12)
    v_mfma_f32_32x32x16_bf16 v[136:151], v[216:219], v[72:75], v[136:151]
    ds_read_b128 v[212:215], v17 offset:45056
    v_mfma_f32_32x32x16_bf16 v[152:167], v[220:223], v[72:75], v[152:167]
    ds_read_b128 v[216:219], v18 offset:14336
    buffer_load_dwordx4 v[104:107], v2, s[24:27], s54 offen offset:0 sc1
    s_waitcnt lgkmcnt(12)
    v_mfma_f32_32x32x16_bf16 v[168:183], v[224:227], v[72:75], v[168:183]
    ds_read_b128 v[220:223], v17 offset:15360
    s_waitcnt lgkmcnt(4)
    v_add_f32 v232, v232, v233
    v_add_f32 v234, v234, v235
    v_add_f32 v236, v236, v237
    s_waitcnt vmcnt(7)
    v_mfma_f32_32x32x16_bf16 v[136:151], v[228:231], v[76:79], v[136:151]
    ds_read_b128 v[224:227], v17 offset:46080
    v_add_f32 v232, v232, v234
    v_add_f32 v236, v236, v238
    v_add_f32 v232, v232, v236
    v_cvt_pk_bf16_f32 v245, v232, v232
    v_mfma_f32_32x32x16_bf16 v[152:167], v[200:203], v[76:79], v[152:167]
    ds_read_b128 v[228:231], v18 offset:15360
    buffer_load_dwordx4 v[108:111], v2, s[24:27], s54 offen offset:1024 sc1
    v_lshlrev_b32 v253, 16, v245
    v_sub_f32 v232, v232, v253
    v_cvt_pk_bf16_f32 v244, v253, v232
    v_mfma_f32_32x32x16_bf16 v[168:183], v[204:207], v[76:79], v[168:183]
    ds_read_b128 v[200:203], v17 offset:16384
    s_waitcnt vmcnt(7)
    s_waitcnt lgkmcnt(5)
    v_mfma_f32_32x32x16_bf16 v[136:151], v[208:211], v[80:83], v[136:151]
    ds_read_b128 v[204:207], v17 offset:47104
    v_mfma_f32_32x32x16_bf16 v[152:167], v[212:215], v[80:83], v[152:167]
    ds_read_b128 v[208:211], v18 offset:16384
    buffer_load_dwordx4 v[112:115], v2, s[24:27], s54 offen offset:2048 sc1
    s_waitcnt lgkmcnt(5)
    v_mfma_f32_32x32x16_bf16 v[168:183], v[216:219], v[80:83], v[168:183]
    ds_read_b128 v[212:215], v17 offset:17408
    s_waitcnt vmcnt(7)
    v_mfma_f32_32x32x16_bf16 v[136:151], v[220:223], v[84:87], v[136:151]
    ds_read_b128 v[216:219], v17 offset:48128
    s_waitcnt lgkmcnt(5)
    v_mfma_f32_32x32x16_bf16 v[152:167], v[224:227], v[84:87], v[152:167]
    ds_read_b128 v[220:223], v18 offset:17408
    buffer_load_dwordx4 v[116:119], v2, s[24:27], s54 offen offset:3072 sc1
    v_mfma_f32_32x32x16_bf16 v[168:183], v[228:231], v[84:87], v[168:183]
    ds_read_b128 v[224:227], v17 offset:18432
    s_waitcnt vmcnt(7)
    s_waitcnt lgkmcnt(5)
    v_mfma_f32_32x32x16_bf16 v[136:151], v[200:203], v[88:91], v[136:151]
    ds_read_b128 v[228:231], v17 offset:49152
    v_mfma_f32_32x32x16_bf16 v[152:167], v[204:207], v[88:91], v[152:167]
    ds_read_b128 v[200:203], v18 offset:18432
    buffer_load_dwordx4 v[120:123], v2, s[24:27], s55 offen offset:0 sc1
    s_waitcnt lgkmcnt(5)
    v_mfma_f32_32x32x16_bf16 v[168:183], v[208:211], v[88:91], v[168:183]
    ds_read_b128 v[204:207], v17 offset:19456
    s_waitcnt vmcnt(7)
    v_mfma_f32_32x32x16_bf16 v[136:151], v[212:215], v[92:95], v[136:151]
    ds_read_b128 v[208:211], v17 offset:50176
    s_waitcnt lgkmcnt(5)
    v_mfma_f32_32x32x16_bf16 v[152:167], v[216:219], v[92:95], v[152:167]
    ds_read_b128 v[212:215], v18 offset:19456
    buffer_load_dwordx4 v[124:127], v2, s[24:27], s55 offen offset:1024 sc1
    v_mfma_f32_32x32x16_bf16 v[168:183], v[220:223], v[92:95], v[168:183]
    ds_read_b128 v[216:219], v17 offset:20480
    s_waitcnt vmcnt(7)
    s_waitcnt lgkmcnt(5)
    v_mfma_f32_32x32x16_bf16 v[136:151], v[224:227], v[96:99], v[136:151]
    ds_read_b128 v[220:223], v17 offset:51200
    v_mfma_f32_32x32x16_bf16 v[152:167], v[228:231], v[96:99], v[152:167]
    ds_read_b128 v[224:227], v18 offset:20480
    buffer_load_dwordx4 v[128:131], v2, s[24:27], s55 offen offset:2048 sc1
    s_waitcnt lgkmcnt(5)
    v_mfma_f32_32x32x16_bf16 v[168:183], v[200:203], v[96:99], v[168:183]
    ds_read_b128 v[228:231], v17 offset:21504
    s_waitcnt vmcnt(7)
    v_mfma_f32_32x32x16_bf16 v[136:151], v[204:207], v[100:103], v[136:151]
    ds_read_b128 v[200:203], v17 offset:52224
    s_waitcnt lgkmcnt(5)
    v_mfma_f32_32x32x16_bf16 v[152:167], v[208:211], v[100:103], v[152:167]
    ds_read_b128 v[204:207], v18 offset:21504
    buffer_load_dwordx4 v[132:135], v2, s[24:27], s55 offen offset:3072 sc1
    v_mfma_f32_32x32x16_bf16 v[168:183], v[212:215], v[100:103], v[168:183]
    ds_read_b128 v[208:211], v17 offset:22528
    s_barrier
    s_waitcnt vmcnt(7)
    s_waitcnt lgkmcnt(5)
    v_mfma_f32_32x32x16_bf16 v[136:151], v[216:219], v[104:107], v[136:151]
    ds_read_b128 v[212:215], v17 offset:53248
    ds_read_b32 v248, v16
    v_mfma_f32_32x32x16_bf16 v[152:167], v[220:223], v[104:107], v[152:167]
    ds_read_b128 v[216:219], v18 offset:22528
    ds_read_b32 v249, v16 offset:256
    s_waitcnt lgkmcnt(7)
    v_mfma_f32_32x32x16_bf16 v[168:183], v[224:227], v[104:107], v[168:183]
    ds_read_b128 v[220:223], v17 offset:23552
    ds_read_b32 v252, v16 offset:512
    s_waitcnt vmcnt(6)
    v_mfma_f32_32x32x16_bf16 v[136:151], v[228:231], v[108:111], v[136:151]
    ds_read_b128 v[224:227], v17 offset:54272
    s_waitcnt lgkmcnt(8)
    v_mfma_f32_32x32x16_bf16 v[152:167], v[200:203], v[108:111], v[152:167]
    ds_read_b128 v[228:231], v18 offset:23552
    v_mfma_f32_32x32x16_bf16 v[168:183], v[204:207], v[108:111], v[168:183]
    ds_read_b128 v[200:203], v17 offset:24576
    s_waitcnt vmcnt(5)
    s_waitcnt lgkmcnt(8)
    v_mfma_f32_32x32x16_bf16 v[136:151], v[208:211], v[112:115], v[136:151]
    ds_read_b128 v[204:207], v17 offset:55296
    v_mfma_f32_32x32x16_bf16 v[152:167], v[212:215], v[112:115], v[152:167]
    ds_read_b128 v[208:211], v18 offset:24576
    s_waitcnt lgkmcnt(6)
    v_mfma_f32_32x32x16_bf16 v[168:183], v[216:219], v[112:115], v[168:183]
    ds_read_b128 v[212:215], v17 offset:25600
    s_waitcnt lgkmcnt(6)
    v_mfma_f32_32x32x16_bf16 v[136:151], v[240:243], v[248:251], v[136:151]
    s_waitcnt vmcnt(4)
    v_mfma_f32_32x32x16_bf16 v[136:151], v[220:223], v[116:119], v[136:151]
    ds_read_b128 v[216:219], v17 offset:56320
    v_mfma_f32_32x32x16_bf16 v[152:167], v[242:245], v[248:251], v[152:167]
    s_waitcnt lgkmcnt(5)
    v_mfma_f32_32x32x16_bf16 v[152:167], v[224:227], v[116:119], v[152:167]
    ds_read_b128 v[220:223], v18 offset:25600
    v_mfma_f32_32x32x16_bf16 v[168:183], v[244:247], v[248:251], v[168:183]
    v_mfma_f32_32x32x16_bf16 v[168:183], v[228:231], v[116:119], v[168:183]
    ds_read_b128 v[224:227], v17 offset:26624
    s_waitcnt vmcnt(3)
    s_waitcnt lgkmcnt(5)
    v_mfma_f32_32x32x16_bf16 v[136:151], v[200:203], v[120:123], v[136:151]
    ds_read_b128 v[228:231], v17 offset:57344
    v_mfma_f32_32x32x16_bf16 v[152:167], v[204:207], v[120:123], v[152:167]
    ds_read_b128 v[200:203], v18 offset:26624
    s_waitcnt lgkmcnt(5)
    v_mfma_f32_32x32x16_bf16 v[168:183], v[208:211], v[120:123], v[168:183]
    ds_read_b128 v[204:207], v17 offset:27648
    s_waitcnt vmcnt(2)
    v_mfma_f32_32x32x16_bf16 v[136:151], v[212:215], v[124:127], v[136:151]
    ds_read_b128 v[208:211], v17 offset:58368
    s_waitcnt lgkmcnt(5)
    v_mfma_f32_32x32x16_bf16 v[152:167], v[216:219], v[124:127], v[152:167]
    ds_read_b128 v[212:215], v18 offset:27648
    v_mfma_f32_32x32x16_bf16 v[168:183], v[220:223], v[124:127], v[168:183]
    ds_read_b128 v[216:219], v19 offset:0
    s_waitcnt vmcnt(1)
    s_waitcnt lgkmcnt(5)
    v_mfma_f32_32x32x16_bf16 v[136:151], v[224:227], v[128:131], v[136:151]
    ds_read_b128 v[220:223], v19 offset:1024
    s_waitcnt lgkmcnt(2)
    s_barrier
    v_mfma_f32_32x32x16_bf16 v[152:167], v[228:231], v[128:131], v[152:167]
    ds_read_b128 v[224:227], v19 offset:2048
    v_mfma_f32_32x32x16_bf16 v[168:183], v[200:203], v[128:131], v[168:183]
    ds_read_b128 v[228:231], v19 offset:3072
    s_waitcnt vmcnt(0)
    v_mfma_f32_32x32x16_bf16 v[136:151], v[204:207], v[132:135], v[136:151]
    ds_read_b128 v[200:203], v19 offset:4096
    v_mfma_f32_32x32x16_bf16 v[152:167], v[208:211], v[132:135], v[152:167]
    ds_read_b128 v[204:207], v19 offset:5120
    v_mfma_f32_32x32x16_bf16 v[168:183], v[212:215], v[132:135], v[168:183]
    ds_read_b128 v[208:211], v19 offset:6144
    s_waitcnt lgkmcnt(5)
    v_mfma_f32_32x32x16_bf16 v[184:199], v[216:219], v[24:27], 0
    ds_read_b128 v[212:215], v19 offset:7168
    v_mfma_f32_32x32x16_bf16 v[184:199], v[220:223], v[28:31], v[184:199]
    ds_read_b128 v[216:219], v19 offset:8192
    ds_read_b32 v232, v22 offset:0
    ds_read_b32 v233, v22 offset:128
    ds_read_b32 v234, v22 offset:256
    s_waitcnt lgkmcnt(8)
    v_mfma_f32_32x32x16_bf16 v[184:199], v[224:227], v[32:35], v[184:199]
    ds_read_b128 v[220:223], v19 offset:9216
    ds_read_b32 v235, v22 offset:384
    ds_read_b32 v236, v22 offset:512
    ds_read_b32 v237, v22 offset:640
    v_mfma_f32_32x32x16_bf16 v[184:199], v[228:231], v[36:39], v[184:199]
    ds_read_b128 v[224:227], v19 offset:10240
    ds_read_b32 v238, v22 offset:768
    s_waitcnt lgkmcnt(12)
    v_mfma_f32_32x32x16_bf16 v[184:199], v[200:203], v[40:43], v[184:199]
    ds_read_b128 v[228:231], v19 offset:11264
    v_max_f32 v136, 0, v136
    v_mul_f32 v144, v144, v252
    v_max_f32 v137, 0, v137
    v_mul_f32 v145, v145, v252
    v_mfma_f32_32x32x16_bf16 v[184:199], v[204:207], v[44:47], v[184:199]
    ds_read_b128 v[200:203], v19 offset:12288
    v_max_f32 v138, 0, v138
    v_mul_f32 v146, v146, v252
    v_max_f32 v139, 0, v139
    v_mul_f32 v147, v147, v252
    s_waitcnt lgkmcnt(12)
    v_mfma_f32_32x32x16_bf16 v[184:199], v[208:211], v[48:51], v[184:199]
    ds_read_b128 v[204:207], v19 offset:13312
    v_max_f32 v140, 0, v140
    v_mul_f32 v148, v148, v252
    v_max_f32 v141, 0, v141
    v_mul_f32 v149, v149, v252
    v_mfma_f32_32x32x16_bf16 v[184:199], v[212:215], v[52:55], v[184:199]
    ds_read_b128 v[208:211], v19 offset:14336
    v_max_f32 v142, 0, v142
    v_mul_f32 v150, v150, v252
    v_max_f32 v143, 0, v143
    v_mul_f32 v151, v151, v252
    s_waitcnt lgkmcnt(9)
    v_mfma_f32_32x32x16_bf16 v[184:199], v[216:219], v[56:59], v[184:199]
    ds_read_b128 v[212:215], v19 offset:15360
    v_mul_f32 v136, v136, v144
    v_mul_f32 v137, v137, v145
    v_mul_f32 v138, v138, v146
    v_mul_f32 v139, v139, v147
    v_mfma_f32_32x32x16_bf16 v[184:199], v[220:223], v[60:63], v[184:199]
    ds_read_b128 v[216:219], v19 offset:16384
    v_mul_f32 v140, v140, v148
    v_mul_f32 v141, v141, v149
    v_mul_f32 v142, v142, v150
    v_mul_f32 v143, v143, v151
    s_waitcnt lgkmcnt(5)
    v_mfma_f32_32x32x16_bf16 v[184:199], v[224:227], v[64:67], v[184:199]
    ds_read_b128 v[220:223], v19 offset:17408
    v_cvt_pk_bf16_f32 v144, v136, v137
    v_cvt_pk_bf16_f32 v145, v138, v139
    v_cvt_pk_bf16_f32 v146, v140, v141
    v_cvt_pk_bf16_f32 v147, v142, v143
    v_mfma_f32_32x32x16_bf16 v[184:199], v[228:231], v[68:71], v[184:199]
    ds_read_b128 v[224:227], v19 offset:18432
    buffer_store_dwordx4 v[144:147], v2, s[24:27], s56 offen offset:0 sc1
    s_waitcnt lgkmcnt(5)
    v_mfma_f32_32x32x16_bf16 v[184:199], v[200:203], v[72:75], v[184:199]
    ds_read_b128 v[228:231], v19 offset:19456
    v_max_f32 v152, 0, v152
    v_mul_f32 v160, v160, v252
    v_max_f32 v153, 0, v153
    v_mul_f32 v161, v161, v252
    v_mfma_f32_32x32x16_bf16 v[184:199], v[204:207], v[76:79], v[184:199]
    ds_read_b128 v[200:203], v19 offset:20480
    v_max_f32 v154, 0, v154
    v_mul_f32 v162, v162, v252
    v_max_f32 v155, 0, v155
    v_mul_f32 v163, v163, v252
    s_waitcnt lgkmcnt(5)
    v_mfma_f32_32x32x16_bf16 v[184:199], v[208:211], v[80:83], v[184:199]
    ds_read_b128 v[204:207], v19 offset:21504
    v_max_f32 v156, 0, v156
    v_mul_f32 v164, v164, v252
    v_max_f32 v157, 0, v157
    v_mul_f32 v165, v165, v252
    v_mfma_f32_32x32x16_bf16 v[184:199], v[212:215], v[84:87], v[184:199]
    ds_read_b128 v[208:211], v19 offset:22528
    v_max_f32 v158, 0, v158
    v_mul_f32 v166, v166, v252
    v_max_f32 v159, 0, v159
    v_mul_f32 v167, v167, v252
    s_waitcnt lgkmcnt(5)
    v_mfma_f32_32x32x16_bf16 v[184:199], v[216:219], v[88:91], v[184:199]
    ds_read_b128 v[212:215], v19 offset:23552
    v_mul_f32 v152, v152, v160
    v_mul_f32 v153, v153, v161
    v_mul_f32 v154, v154, v162
    v_mul_f32 v155, v155, v163
    v_mfma_f32_32x32x16_bf16 v[184:199], v[220:223], v[92:95], v[184:199]
    ds_read_b128 v[216:219], v19 offset:24576
    v_mul_f32 v156, v156, v164
    v_mul_f32 v157, v157, v165
    v_mul_f32 v158, v158, v166
    v_mul_f32 v159, v159, v167
    s_waitcnt lgkmcnt(5)
    v_mfma_f32_32x32x16_bf16 v[184:199], v[224:227], v[96:99], v[184:199]
    ds_read_b128 v[220:223], v19 offset:25600
    v_cvt_pk_bf16_f32 v160, v152, v153
    v_cvt_pk_bf16_f32 v161, v154, v155
    v_cvt_pk_bf16_f32 v162, v156, v157
    v_cvt_pk_bf16_f32 v163, v158, v159
    v_mfma_f32_32x32x16_bf16 v[184:199], v[228:231], v[100:103], v[184:199]
    ds_read_b128 v[224:227], v19 offset:26624
    buffer_store_dwordx4 v[160:163], v2, s[24:27], s56 offen offset:1024 sc1
    s_waitcnt lgkmcnt(5)
    v_mfma_f32_32x32x16_bf16 v[184:199], v[200:203], v[104:107], v[184:199]
    ds_read_b128 v[228:231], v19 offset:27648
    v_add_f32 v232, v232, v233
    v_add_f32 v234, v234, v235
    v_add_f32 v236, v236, v237
    v_mfma_f32_32x32x16_bf16 v[184:199], v[204:207], v[108:111], v[184:199]
    ds_read_b128 v[200:203], v19 offset:30720
    v_add_f32 v232, v232, v234
    v_add_f32 v236, v236, v238
    v_add_f32 v232, v232, v236
    v_cvt_pk_bf16_f32 v245, v232, v232
    s_waitcnt lgkmcnt(5)
    v_mfma_f32_32x32x16_bf16 v[184:199], v[208:211], v[112:115], v[184:199]
    ds_read_b128 v[204:207], v19 offset:31744
    v_lshlrev_b32 v253, 16, v245
    v_sub_f32 v232, v232, v253
    v_cvt_pk_bf16_f32 v244, v253, v232
    v_mfma_f32_32x32x16_bf16 v[184:199], v[212:215], v[116:119], v[184:199]
    ds_read_b128 v[208:211], v19 offset:32768
    s_waitcnt lgkmcnt(5)
    v_mfma_f32_32x32x16_bf16 v[184:199], v[216:219], v[120:123], v[184:199]
    ds_read_b128 v[212:215], v19 offset:33792
    v_mfma_f32_32x32x16_bf16 v[184:199], v[244:247], v[248:251], v[184:199]
    v_mfma_f32_32x32x16_bf16 v[184:199], v[220:223], v[124:127], v[184:199]
    ds_read_b128 v[216:219], v19 offset:34816
    s_waitcnt lgkmcnt(5)
    v_mfma_f32_32x32x16_bf16 v[184:199], v[224:227], v[128:131], v[184:199]
    ds_read_b128 v[220:223], v19 offset:35840
    v_mfma_f32_32x32x16_bf16 v[184:199], v[228:231], v[132:135], v[184:199]
    ds_read_b128 v[224:227], v19 offset:36864
    s_waitcnt lgkmcnt(5)
    v_mfma_f32_32x32x16_bf16 v[136:151], v[200:203], v[24:27], 0
    ds_read_b128 v[228:231], v19 offset:37888
    v_mfma_f32_32x32x16_bf16 v[136:151], v[204:207], v[28:31], v[136:151]
    ds_read_b128 v[200:203], v19 offset:38912
    ds_read_b32 v232, v22 offset:30720
    ds_read_b32 v233, v22 offset:30848
    ds_read_b32 v234, v22 offset:30976
    s_waitcnt lgkmcnt(8)
    v_mfma_f32_32x32x16_bf16 v[136:151], v[208:211], v[32:35], v[136:151]
    ds_read_b128 v[204:207], v19 offset:39936
    ds_read_b32 v235, v22 offset:31104
    ds_read_b32 v236, v22 offset:31232
    ds_read_b32 v237, v22 offset:31360
    v_mfma_f32_32x32x16_bf16 v[136:151], v[212:215], v[36:39], v[136:151]
    ds_read_b128 v[208:211], v19 offset:40960
    ds_read_b32 v238, v22 offset:31488
    s_waitcnt lgkmcnt(12)
    v_mfma_f32_32x32x16_bf16 v[136:151], v[216:219], v[40:43], v[136:151]
    ds_read_b128 v[212:215], v19 offset:41984
    v_max_f32 v168, 0, v168
    v_mul_f32 v176, v176, v252
    v_max_f32 v169, 0, v169
    v_mul_f32 v177, v177, v252
    v_mfma_f32_32x32x16_bf16 v[136:151], v[220:223], v[44:47], v[136:151]
    ds_read_b128 v[216:219], v19 offset:43008
    v_max_f32 v170, 0, v170
    v_mul_f32 v178, v178, v252
    v_max_f32 v171, 0, v171
    v_mul_f32 v179, v179, v252
    s_waitcnt lgkmcnt(12)
    v_mfma_f32_32x32x16_bf16 v[136:151], v[224:227], v[48:51], v[136:151]
    ds_read_b128 v[220:223], v19 offset:44032
    v_max_f32 v172, 0, v172
    v_mul_f32 v180, v180, v252
    v_max_f32 v173, 0, v173
    v_mul_f32 v181, v181, v252
    v_mfma_f32_32x32x16_bf16 v[136:151], v[228:231], v[52:55], v[136:151]
    ds_read_b128 v[224:227], v19 offset:45056
    v_max_f32 v174, 0, v174
    v_mul_f32 v182, v182, v252
    v_max_f32 v175, 0, v175
    v_mul_f32 v183, v183, v252
    s_waitcnt lgkmcnt(9)
    v_mfma_f32_32x32x16_bf16 v[136:151], v[200:203], v[56:59], v[136:151]
    ds_read_b128 v[228:231], v19 offset:46080
    v_mul_f32 v168, v168, v176
    v_mul_f32 v169, v169, v177
    v_mul_f32 v170, v170, v178
    v_mul_f32 v171, v171, v179
    v_mfma_f32_32x32x16_bf16 v[136:151], v[204:207], v[60:63], v[136:151]
    ds_read_b128 v[200:203], v19 offset:47104
    v_mul_f32 v172, v172, v180
    v_mul_f32 v173, v173, v181
    v_mul_f32 v174, v174, v182
    v_mul_f32 v175, v175, v183
    s_waitcnt lgkmcnt(5)
    v_mfma_f32_32x32x16_bf16 v[136:151], v[208:211], v[64:67], v[136:151]
    ds_read_b128 v[204:207], v19 offset:48128
    v_cvt_pk_bf16_f32 v176, v168, v169
    v_cvt_pk_bf16_f32 v177, v170, v171
    v_cvt_pk_bf16_f32 v178, v172, v173
    v_cvt_pk_bf16_f32 v179, v174, v175
    v_mfma_f32_32x32x16_bf16 v[136:151], v[212:215], v[68:71], v[136:151]
    ds_read_b128 v[208:211], v19 offset:49152
    buffer_store_dwordx4 v[176:179], v2, s[24:27], s56 offen offset:2048 sc1
    s_waitcnt lgkmcnt(5)
    v_mfma_f32_32x32x16_bf16 v[136:151], v[216:219], v[72:75], v[136:151]
    ds_read_b128 v[212:215], v19 offset:50176
    v_max_f32 v184, 0, v184
    v_mul_f32 v192, v192, v252
    v_max_f32 v185, 0, v185
    v_mul_f32 v193, v193, v252
    v_mfma_f32_32x32x16_bf16 v[136:151], v[220:223], v[76:79], v[136:151]
    ds_read_b128 v[216:219], v19 offset:51200
    v_max_f32 v186, 0, v186
    v_mul_f32 v194, v194, v252
    v_max_f32 v187, 0, v187
    v_mul_f32 v195, v195, v252
    s_waitcnt lgkmcnt(5)
    v_mfma_f32_32x32x16_bf16 v[136:151], v[224:227], v[80:83], v[136:151]
    ds_read_b128 v[220:223], v19 offset:52224
    v_max_f32 v188, 0, v188
    v_mul_f32 v196, v196, v252
    v_max_f32 v189, 0, v189
    v_mul_f32 v197, v197, v252
    v_mfma_f32_32x32x16_bf16 v[136:151], v[228:231], v[84:87], v[136:151]
    ds_read_b128 v[224:227], v19 offset:53248
    v_max_f32 v190, 0, v190
    v_mul_f32 v198, v198, v252
    v_max_f32 v191, 0, v191
    v_mul_f32 v199, v199, v252
    s_waitcnt lgkmcnt(5)
    v_mfma_f32_32x32x16_bf16 v[136:151], v[200:203], v[88:91], v[136:151]
    ds_read_b128 v[228:231], v19 offset:54272
    v_mul_f32 v184, v184, v192
    v_mul_f32 v185, v185, v193
    v_mul_f32 v186, v186, v194
    v_mul_f32 v187, v187, v195
    v_mfma_f32_32x32x16_bf16 v[136:151], v[204:207], v[92:95], v[136:151]
    ds_read_b128 v[200:203], v19 offset:55296
    v_mul_f32 v188, v188, v196
    v_mul_f32 v189, v189, v197
    v_mul_f32 v190, v190, v198
    v_mul_f32 v191, v191, v199
    s_waitcnt lgkmcnt(5)
    v_mfma_f32_32x32x16_bf16 v[136:151], v[208:211], v[96:99], v[136:151]
    ds_read_b128 v[204:207], v19 offset:56320
    v_cvt_pk_bf16_f32 v192, v184, v185
    v_cvt_pk_bf16_f32 v193, v186, v187
    v_cvt_pk_bf16_f32 v194, v188, v189
    v_cvt_pk_bf16_f32 v195, v190, v191
    v_mfma_f32_32x32x16_bf16 v[136:151], v[212:215], v[100:103], v[136:151]
    ds_read_b128 v[208:211], v19 offset:57344
    buffer_store_dwordx4 v[192:195], v2, s[24:27], s56 offen offset:3072 sc1
    s_waitcnt lgkmcnt(5)
    v_mfma_f32_32x32x16_bf16 v[136:151], v[216:219], v[104:107], v[136:151]
    ds_read_b128 v[212:215], v19 offset:58368
    v_add_f32 v232, v232, v233
    v_add_f32 v234, v234, v235
    v_add_f32 v236, v236, v237
    v_mfma_f32_32x32x16_bf16 v[136:151], v[220:223], v[108:111], v[136:151]
    v_add_f32 v232, v232, v234
    v_add_f32 v236, v236, v238
    v_add_f32 v232, v232, v236
    v_cvt_pk_bf16_f32 v245, v232, v232
    s_waitcnt lgkmcnt(4)
    v_mfma_f32_32x32x16_bf16 v[136:151], v[224:227], v[112:115], v[136:151]
    v_lshlrev_b32 v253, 16, v245
    v_sub_f32 v232, v232, v253
    v_cvt_pk_bf16_f32 v244, v253, v232
    s_waitcnt lgkmcnt(0)
    s_barrier
    v_mfma_f32_32x32x16_bf16 v[136:151], v[228:231], v[116:119], v[136:151]
    ds_read_b128 v[216:219], v17 offset:0
    ds_read_b128 v[220:223], v17 offset:1024
    v_mfma_f32_32x32x16_bf16 v[136:151], v[200:203], v[120:123], v[136:151]
    ds_read_b128 v[224:227], v17 offset:2048
    ds_read_b128 v[228:231], v17 offset:3072
    v_mfma_f32_32x32x16_bf16 v[136:151], v[244:247], v[248:251], v[136:151]
    v_mfma_f32_32x32x16_bf16 v[136:151], v[204:207], v[124:127], v[136:151]
    ds_read_b128 v[200:203], v17 offset:4096
    v_mfma_f32_32x32x16_bf16 v[136:151], v[208:211], v[128:131], v[136:151]
    ds_read_b128 v[204:207], v17 offset:5120
    v_mfma_f32_32x32x16_bf16 v[136:151], v[212:215], v[132:135], v[136:151]
    ds_read_b128 v[208:211], v17 offset:6144
    s_waitcnt lgkmcnt(5)
    v_mfma_f32_32x32x16_bf16 v[152:167], v[216:219], v[24:27], 0
    ds_read_b128 v[212:215], v17 offset:7168
    v_mfma_f32_32x32x16_bf16 v[152:167], v[220:223], v[28:31], v[152:167]
    ds_read_b128 v[216:219], v17 offset:8192
    ds_read_b32 v232, v20 offset:0
    ds_read_b32 v233, v20 offset:128
    ds_read_b32 v234, v20 offset:256
    s_waitcnt lgkmcnt(8)
    v_mfma_f32_32x32x16_bf16 v[152:167], v[224:227], v[32:35], v[152:167]
    ds_read_b128 v[220:223], v17 offset:9216
    ds_read_b32 v235, v20 offset:384
    ds_read_b32 v236, v20 offset:512
    ds_read_b32 v237, v20 offset:640
    v_mfma_f32_32x32x16_bf16 v[152:167], v[228:231], v[36:39], v[152:167]
    ds_read_b128 v[224:227], v17 offset:10240
    ds_read_b32 v238, v20 offset:768
    s_waitcnt lgkmcnt(12)
    v_mfma_f32_32x32x16_bf16 v[152:167], v[200:203], v[40:43], v[152:167]
    ds_read_b128 v[228:231], v17 offset:11264
    v_max_f32 v136, 0, v136
    v_mul_f32 v144, v144, v252
    v_max_f32 v137, 0, v137
    v_mul_f32 v145, v145, v252
    v_mfma_f32_32x32x16_bf16 v[152:167], v[204:207], v[44:47], v[152:167]
    ds_read_b128 v[200:203], v17 offset:12288
    v_max_f32 v138, 0, v138
    v_mul_f32 v146, v146, v252
    v_max_f32 v139, 0, v139
    v_mul_f32 v147, v147, v252
    s_waitcnt lgkmcnt(12)
    v_mfma_f32_32x32x16_bf16 v[152:167], v[208:211], v[48:51], v[152:167]
    ds_read_b128 v[204:207], v17 offset:13312
    v_max_f32 v140, 0, v140
    v_mul_f32 v148, v148, v252
    v_max_f32 v141, 0, v141
    v_mul_f32 v149, v149, v252
    v_mfma_f32_32x32x16_bf16 v[152:167], v[212:215], v[52:55], v[152:167]
    ds_read_b128 v[208:211], v17 offset:14336
    v_max_f32 v142, 0, v142
    v_mul_f32 v150, v150, v252
    v_max_f32 v143, 0, v143
    v_mul_f32 v151, v151, v252
    s_waitcnt lgkmcnt(9)
    v_mfma_f32_32x32x16_bf16 v[152:167], v[216:219], v[56:59], v[152:167]
    ds_read_b128 v[212:215], v17 offset:15360
    v_mul_f32 v136, v136, v144
    v_mul_f32 v137, v137, v145
    v_mul_f32 v138, v138, v146
    v_mul_f32 v139, v139, v147
    v_mfma_f32_32x32x16_bf16 v[152:167], v[220:223], v[60:63], v[152:167]
    ds_read_b128 v[216:219], v17 offset:16384
    v_mul_f32 v140, v140, v148
    v_mul_f32 v141, v141, v149
    v_mul_f32 v142, v142, v150
    v_mul_f32 v143, v143, v151
    s_waitcnt lgkmcnt(5)
    v_mfma_f32_32x32x16_bf16 v[152:167], v[224:227], v[64:67], v[152:167]
    ds_read_b128 v[220:223], v17 offset:17408
    v_cvt_pk_bf16_f32 v144, v136, v137
    v_cvt_pk_bf16_f32 v145, v138, v139
    v_cvt_pk_bf16_f32 v146, v140, v141
    v_cvt_pk_bf16_f32 v147, v142, v143
    v_mfma_f32_32x32x16_bf16 v[152:167], v[228:231], v[68:71], v[152:167]
    ds_read_b128 v[224:227], v17 offset:18432
    buffer_store_dwordx4 v[144:147], v2, s[24:27], s57 offen offset:0 sc1
    s_waitcnt lgkmcnt(5)
    v_mfma_f32_32x32x16_bf16 v[152:167], v[200:203], v[72:75], v[152:167]
    ds_read_b128 v[228:231], v17 offset:19456
    v_mfma_f32_32x32x16_bf16 v[152:167], v[204:207], v[76:79], v[152:167]
    ds_read_b128 v[200:203], v17 offset:20480
    s_waitcnt lgkmcnt(5)
    v_mfma_f32_32x32x16_bf16 v[152:167], v[208:211], v[80:83], v[152:167]
    ds_read_b128 v[204:207], v17 offset:21504
    v_mfma_f32_32x32x16_bf16 v[152:167], v[212:215], v[84:87], v[152:167]
    ds_read_b128 v[208:211], v17 offset:22528
    s_waitcnt lgkmcnt(5)
    v_mfma_f32_32x32x16_bf16 v[152:167], v[216:219], v[88:91], v[152:167]
    ds_read_b128 v[212:215], v17 offset:23552
    v_mfma_f32_32x32x16_bf16 v[152:167], v[220:223], v[92:95], v[152:167]
    ds_read_b128 v[216:219], v17 offset:24576
    s_waitcnt lgkmcnt(5)
    v_mfma_f32_32x32x16_bf16 v[152:167], v[224:227], v[96:99], v[152:167]
    ds_read_b128 v[220:223], v17 offset:25600
    v_mfma_f32_32x32x16_bf16 v[152:167], v[228:231], v[100:103], v[152:167]
    ds_read_b128 v[224:227], v17 offset:26624
    s_waitcnt lgkmcnt(5)
    v_mfma_f32_32x32x16_bf16 v[152:167], v[200:203], v[104:107], v[152:167]
    ds_read_b128 v[228:231], v17 offset:27648
    v_add_f32 v232, v232, v233
    v_add_f32 v234, v234, v235
    v_add_f32 v236, v236, v237
    v_mfma_f32_32x32x16_bf16 v[152:167], v[204:207], v[108:111], v[152:167]
    ds_read_b128 v[200:203], v17 offset:30720
    v_add_f32 v232, v232, v234
    v_add_f32 v236, v236, v238
    v_add_f32 v232, v232, v236
    v_cvt_pk_bf16_f32 v245, v232, v232
    s_waitcnt lgkmcnt(5)
    v_mfma_f32_32x32x16_bf16 v[152:167], v[208:211], v[112:115], v[152:167]
    ds_read_b128 v[204:207], v17 offset:31744
    v_lshlrev_b32 v253, 16, v245
    v_sub_f32 v232, v232, v253
    v_cvt_pk_bf16_f32 v244, v253, v232
    v_mfma_f32_32x32x16_bf16 v[152:167], v[212:215], v[116:119], v[152:167]
    ds_read_b128 v[208:211], v17 offset:32768
    s_waitcnt lgkmcnt(5)
    v_mfma_f32_32x32x16_bf16 v[152:167], v[216:219], v[120:123], v[152:167]
    ds_read_b128 v[212:215], v17 offset:33792
    v_mfma_f32_32x32x16_bf16 v[152:167], v[244:247], v[248:251], v[152:167]
    v_mfma_f32_32x32x16_bf16 v[152:167], v[220:223], v[124:127], v[152:167]
    ds_read_b128 v[216:219], v17 offset:34816
    s_waitcnt lgkmcnt(5)
    v_mfma_f32_32x32x16_bf16 v[152:167], v[224:227], v[128:131], v[152:167]
    ds_read_b128 v[220:223], v17 offset:35840
    v_mfma_f32_32x32x16_bf16 v[152:167], v[228:231], v[132:135], v[152:167]
    ds_read_b128 v[224:227], v17 offset:36864
    s_waitcnt lgkmcnt(5)
    v_mfma_f32_32x32x16_bf16 v[168:183], v[200:203], v[24:27], 0
    ds_read_b128 v[228:231], v17 offset:37888
    v_mfma_f32_32x32x16_bf16 v[168:183], v[204:207], v[28:31], v[168:183]
    ds_read_b128 v[200:203], v17 offset:38912
    ds_read_b32 v232, v20 offset:30720
    ds_read_b32 v233, v20 offset:30848
    ds_read_b32 v234, v20 offset:30976
    s_waitcnt lgkmcnt(8)
    v_mfma_f32_32x32x16_bf16 v[168:183], v[208:211], v[32:35], v[168:183]
    ds_read_b128 v[204:207], v17 offset:39936
    ds_read_b32 v235, v20 offset:31104
    ds_read_b32 v236, v20 offset:31232
    ds_read_b32 v237, v20 offset:31360
    v_mfma_f32_32x32x16_bf16 v[168:183], v[212:215], v[36:39], v[168:183]
    ds_read_b128 v[208:211], v17 offset:40960
    ds_read_b32 v238, v20 offset:31488
    s_waitcnt lgkmcnt(12)
    v_mfma_f32_32x32x16_bf16 v[168:183], v[216:219], v[40:43], v[168:183]
    ds_read_b128 v[212:215], v17 offset:41984
    v_max_f32 v152, 0, v152
    v_mul_f32 v160, v160, v252
    v_max_f32 v153, 0, v153
    v_mul_f32 v161, v161, v252
    v_mfma_f32_32x32x16_bf16 v[168:183], v[220:223], v[44:47], v[168:183]
    ds_read_b128 v[216:219], v17 offset:43008
    v_max_f32 v154, 0, v154
    v_mul_f32 v162, v162, v252
    v_max_f32 v155, 0, v155
    v_mul_f32 v163, v163, v252
    s_waitcnt lgkmcnt(12)
    v_mfma_f32_32x32x16_bf16 v[168:183], v[224:227], v[48:51], v[168:183]
    ds_read_b128 v[220:223], v17 offset:44032
    v_max_f32 v156, 0, v156
    v_mul_f32 v164, v164, v252
    v_max_f32 v157, 0, v157
    v_mul_f32 v165, v165, v252
    v_mfma_f32_32x32x16_bf16 v[168:183], v[228:231], v[52:55], v[168:183]
    ds_read_b128 v[224:227], v17 offset:45056
    v_max_f32 v158, 0, v158
    v_mul_f32 v166, v166, v252
    v_max_f32 v159, 0, v159
    v_mul_f32 v167, v167, v252
    s_waitcnt lgkmcnt(9)
    v_mfma_f32_32x32x16_bf16 v[168:183], v[200:203], v[56:59], v[168:183]
    ds_read_b128 v[228:231], v17 offset:46080
    v_mul_f32 v152, v152, v160
    v_mul_f32 v153, v153, v161
    v_mul_f32 v154, v154, v162
    v_mul_f32 v155, v155, v163
    v_mfma_f32_32x32x16_bf16 v[168:183], v[204:207], v[60:63], v[168:183]
    ds_read_b128 v[200:203], v17 offset:47104
    v_mul_f32 v156, v156, v164
    v_mul_f32 v157, v157, v165
    v_mul_f32 v158, v158, v166
    v_mul_f32 v159, v159, v167
    s_waitcnt lgkmcnt(5)
    v_mfma_f32_32x32x16_bf16 v[168:183], v[208:211], v[64:67], v[168:183]
    ds_read_b128 v[204:207], v17 offset:48128
    v_cvt_pk_bf16_f32 v160, v152, v153
    v_cvt_pk_bf16_f32 v161, v154, v155
    v_cvt_pk_bf16_f32 v162, v156, v157
    v_cvt_pk_bf16_f32 v163, v158, v159
    v_mfma_f32_32x32x16_bf16 v[168:183], v[212:215], v[68:71], v[168:183]
    ds_read_b128 v[208:211], v17 offset:49152
    buffer_store_dwordx4 v[160:163], v2, s[24:27], s57 offen offset:1024 sc1
    s_waitcnt lgkmcnt(5)
    v_mfma_f32_32x32x16_bf16 v[168:183], v[216:219], v[72:75], v[168:183]
    ds_read_b128 v[212:215], v17 offset:50176
    v_mfma_f32_32x32x16_bf16 v[168:183], v[220:223], v[76:79], v[168:183]
    ds_read_b128 v[216:219], v17 offset:51200
    s_waitcnt lgkmcnt(5)
    v_mfma_f32_32x32x16_bf16 v[168:183], v[224:227], v[80:83], v[168:183]
    ds_read_b128 v[220:223], v17 offset:52224
    v_mfma_f32_32x32x16_bf16 v[168:183], v[228:231], v[84:87], v[168:183]
    ds_read_b128 v[224:227], v17 offset:53248
    s_waitcnt lgkmcnt(5)
    v_mfma_f32_32x32x16_bf16 v[168:183], v[200:203], v[88:91], v[168:183]
    ds_read_b128 v[228:231], v17 offset:54272
    v_mfma_f32_32x32x16_bf16 v[168:183], v[204:207], v[92:95], v[168:183]
    ds_read_b128 v[200:203], v17 offset:55296
    s_waitcnt lgkmcnt(5)
    v_mfma_f32_32x32x16_bf16 v[168:183], v[208:211], v[96:99], v[168:183]
    ds_read_b128 v[204:207], v17 offset:56320
    v_mfma_f32_32x32x16_bf16 v[168:183], v[212:215], v[100:103], v[168:183]
    ds_read_b128 v[208:211], v17 offset:57344
    s_waitcnt lgkmcnt(5)
    v_mfma_f32_32x32x16_bf16 v[168:183], v[216:219], v[104:107], v[168:183]
    ds_read_b128 v[212:215], v17 offset:58368
    v_add_f32 v232, v232, v233
    v_add_f32 v234, v234, v235
    v_add_f32 v236, v236, v237
    v_mfma_f32_32x32x16_bf16 v[168:183], v[220:223], v[108:111], v[168:183]
    v_add_f32 v232, v232, v234
    v_add_f32 v236, v236, v238
    v_add_f32 v232, v232, v236
    v_cvt_pk_bf16_f32 v245, v232, v232
    s_waitcnt lgkmcnt(4)
    v_mfma_f32_32x32x16_bf16 v[168:183], v[224:227], v[112:115], v[168:183]
    v_lshlrev_b32 v253, 16, v245
    v_sub_f32 v232, v232, v253
    v_cvt_pk_bf16_f32 v244, v253, v232
    v_mfma_f32_32x32x16_bf16 v[168:183], v[228:231], v[116:119], v[168:183]
    s_waitcnt lgkmcnt(2)
    v_mfma_f32_32x32x16_bf16 v[168:183], v[200:203], v[120:123], v[168:183]
    v_mfma_f32_32x32x16_bf16 v[168:183], v[244:247], v[248:251], v[168:183]
    v_mfma_f32_32x32x16_bf16 v[168:183], v[204:207], v[124:127], v[168:183]
    s_waitcnt lgkmcnt(0)
    v_mfma_f32_32x32x16_bf16 v[168:183], v[208:211], v[128:131], v[168:183]
    v_mfma_f32_32x32x16_bf16 v[168:183], v[212:215], v[132:135], v[168:183]
    s_nop 11
    v_max_f32 v168, 0, v168
    v_mul_f32 v176, v176, v252
    v_max_f32 v169, 0, v169
    v_mul_f32 v177, v177, v252
    v_max_f32 v170, 0, v170
    v_mul_f32 v178, v178, v252
    v_max_f32 v171, 0, v171
    v_mul_f32 v179, v179, v252
    v_max_f32 v172, 0, v172
    v_mul_f32 v180, v180, v252
    v_max_f32 v173, 0, v173
    v_mul_f32 v181, v181, v252
    v_max_f32 v174, 0, v174
    v_mul_f32 v182, v182, v252
    v_max_f32 v175, 0, v175
    v_mul_f32 v183, v183, v252
    v_mul_f32 v168, v168, v176
    v_mul_f32 v169, v169, v177
    v_mul_f32 v170, v170, v178
    v_mul_f32 v171, v171, v179
    v_mul_f32 v172, v172, v180
    v_mul_f32 v173, v173, v181
    v_mul_f32 v174, v174, v182
    v_mul_f32 v175, v175, v183
    v_cvt_pk_bf16_f32 v176, v168, v169
    v_cvt_pk_bf16_f32 v177, v170, v171
    v_cvt_pk_bf16_f32 v178, v172, v173
    v_cvt_pk_bf16_f32 v179, v174, v175
    buffer_store_dwordx4 v[176:179], v2, s[24:27], s57 offen offset:2048 sc1
    s_mov_b32 s36, s39
    s_lshl_b32 s37, s38, 8
    s_add_u32 s37, s37, s36
    s_lshl_b32 s37, s37, 3
    s_add_u32 s37, s37, 23658496
    v_lshlrev_b32 v8, 7, v1
    s_waitcnt vmcnt(0)
    v_mov_b32 v6, 163784
    v_mov_b32 v7, 1
    s_mov_b64 exec, 1
    ds_add_rtn_u32 v7, v6, v7
    s_waitcnt lgkmcnt(0)
    v_readfirstlane_b32 s34, v7
    s_mov_b64 exec, -1
    s_cmp_lg_u32 s34, 3
    s_cbranch_scc1 AR_sequential_preLN__softmax_full_mha__glu_gated_reglu__prompt_kernel_52
    s_mov_b64 exec, 0x7f7f
    buffer_store_dwordx2 v[4:5], v8, s[24:27], s37 offen sc1
    s_mov_b64 exec, -1
AR_sequential_preLN__softmax_full_mha__glu_gated_reglu__prompt_kernel_52:
P4J_sequential_preLN__softmax_full_mha__glu_gated_reglu__prompt_kernel_48:
    s_barrier
    s_cmp_ge_u32 s2, 224
    s_cbranch_scc1 P35X_sequential_preLN__softmax_full_mha__glu_gated_reglu__prompt_kernel_53
    s_and_b32 s51, s2, 7
    s_lshl_b32 s51, s51, 2
    s_bfe_u32 s52, s2, 0x20003
    s_add_u32 s48, s51, s52
    s_lshr_b32 s49, s2, 5
    s_lshr_b32 s50, s28, 2
    s_and_b32 s51, s29, 1
    s_lshl_b32 s51, s51, 8
    v_xor_b32 v16, s51, v2
    s_mov_b32 s59, 0
    s_cmp_ge_u32 s28, 4
    s_cbranch_scc1 P5W_sequential_preLN__softmax_full_mha__glu_gated_reglu__prompt_kernel_55
    s_cmp_lg_u32 s28, 3
    s_cbranch_scc1 P5W3_sequential_preLN__softmax_full_mha__glu_gated_reglu__prompt_kernel_56
    s_mul_i32 s51, s49, 229376
    s_add_u32 s52, s51, 18108416
    buffer_load_dwordx4 v[140:143], v16, s[24:27], s52 offen offset:0 sc1
    buffer_load_dwordx4 v[144:147], v16, s[24:27], s52 offen offset:1024 sc1
    buffer_load_dwordx4 v[148:151], v16, s[24:27], s52 offen offset:2048 sc1
    buffer_load_dwordx4 v[152:155], v16, s[24:27], s52 offen offset:3072 sc1
    s_add_u32 s52, s51, 18112512
    buffer_load_dwordx4 v[156:159], v16, s[24:27], s52 offen offset:0 sc1
    buffer_load_dwordx4 v[160:163], v16, s[24:27], s52 offen offset:1024 sc1
    buffer_load_dwordx4 v[164:167], v16, s[24:27], s52 offen offset:2048 sc1
    buffer_load_dwordx4 v[168:171], v16, s[24:27], s52 offen offset:3072 sc1
    s_add_u32 s52, s51, 18116608
    buffer_load_dwordx4 v[172:175], v16, s[24:27], s52 offen offset:0 sc1
    buffer_load_dwordx4 v[176:179], v16, s[24:27], s52 offen offset:1024 sc1
    buffer_load_dwordx4 v[180:183], v16, s[24:27], s52 offen offset:2048 sc1
    buffer_load_dwordx4 v[184:187], v16, s[24:27], s52 offen offset:3072 sc1
    s_add_u32 s52, s51, 18120704
    buffer_load_dwordx4 v[188:191], v16, s[24:27], s52 offen offset:0 sc1
    buffer_load_dwordx4 v[192:195], v16, s[24:27], s52 offen offset:1024 sc1
    buffer_load_dwordx4 v[196:199], v16, s[24:27], s52 offen offset:2048 sc1
    buffer_load_dwordx4 v[200:203], v16, s[24:27], s52 offen offset:3072 sc1
    s_add_u32 s52, s51, 18124800
    buffer_load_dwordx4 v[204:207], v16, s[24:27], s52 offen offset:0 sc1
    buffer_load_dwordx4 v[208:211], v16, s[24:27], s52 offen offset:1024 sc1
    buffer_load_dwordx4 v[212:215], v16, s[24:27], s52 offen offset:2048 sc1
    buffer_load_dwordx4 v[216:219], v16, s[24:27], s52 offen offset:3072 sc1
    s_add_u32 s52, s51, 18128896
    buffer_load_dwordx4 v[220:223], v16, s[24:27], s52 offen offset:0 sc1
    buffer_load_dwordx4 v[224:227], v16, s[24:27], s52 offen offset:1024 sc1
    buffer_load_dwordx4 v[228:231], v16, s[24:27], s52 offen offset:2048 sc1
    buffer_load_dwordx4 v[232:235], v16, s[24:27], s52 offen offset:3072 sc1
    s_add_u32 s52, s51, 18132992
    buffer_load_dwordx4 v[236:239], v16, s[24:27], s52 offen offset:0 sc1
    buffer_load_dwordx4 v[240:243], v16, s[24:27], s52 offen offset:1024 sc1
    buffer_load_dwordx4 v[244:247], v16, s[24:27], s52 offen offset:2048 sc1
    buffer_load_dwordx4 v[248:251], v16, s[24:27], s52 offen offset:3072 sc1
    s_branch P5W_sequential_preLN__softmax_full_mha__glu_gated_reglu__prompt_kernel_55
P5W3_sequential_preLN__softmax_full_mha__glu_gated_reglu__prompt_kernel_56:
    s_mov_b32 s51, 126976
    s_cmp_eq_u32 s29, 1
    s_cselect_b32 s51, 0, s51
    s_cmp_eq_u32 s29, 2
    s_cselect_b32 s51, 30720, s51
    s_cmp_eq_u32 s29, 3
    s_cselect_b32 s51, 65536, s51
    v_add_u32 v16, s51, v16
    s_lshl_b32 s51, s59, 12
    v_add_u32 v22, s51, v16
    s_add_u32 s59, s59, 1
    s_cmp_eq_u32 s59, 7
    s_cselect_b32 s59, 0, s59
    ds_read_b128 v[140:143], v22 offset:0
    ds_read_b128 v[144:147], v22 offset:1024
    ds_read_b128 v[148:151], v22 offset:2048
    ds_read_b128 v[152:155], v22 offset:3072
    s_lshl_b32 s51, s59, 12
    v_add_u32 v22, s51, v16
    s_add_u32 s59, s59, 1
    s_cmp_eq_u32 s59, 7
    s_cselect_b32 s59, 0, s59
    ds_read_b128 v[156:159], v22 offset:0
    ds_read_b128 v[160:163], v22 offset:1024
    ds_read_b128 v[164:167], v22 offset:2048
    ds_read_b128 v[168:171], v22 offset:3072
    s_lshl_b32 s51, s59, 12
    v_add_u32 v22, s51, v16
    s_add_u32 s59, s59, 1
    s_cmp_eq_u32 s59, 7
    s_cselect_b32 s59, 0, s59
    ds_read_b128 v[172:175], v22 offset:0
    ds_read_b128 v[176:179], v22 offset:1024
    ds_read_b128 v[180:183], v22 offset:2048
    ds_read_b128 v[184:187], v22 offset:3072
    s_lshl_b32 s51, s59, 12
    v_add_u32 v22, s51, v16
    s_add_u32 s59, s59, 1
    s_cmp_eq_u32 s59, 7
    s_cselect_b32 s59, 0, s59
    ds_read_b128 v[188:191], v22 offset:0
    ds_read_b128 v[192:195], v22 offset:1024
    ds_read_b128 v[196:199], v22 offset:2048
    ds_read_b128 v[200:203], v22 offset:3072
    s_lshl_b32 s51, s59, 12
    v_add_u32 v22, s51, v16
    s_add_u32 s59, s59, 1
    s_cmp_eq_u32 s59, 7
    s_cselect_b32 s59, 0, s59
    ds_read_b128 v[204:207], v22 offset:0
    ds_read_b128 v[208:211], v22 offset:1024
    ds_read_b128 v[212:215], v22 offset:2048
    ds_read_b128 v[216:219], v22 offset:3072
    s_lshl_b32 s51, s59, 12
    v_add_u32 v22, s51, v16
    s_add_u32 s59, s59, 1
    s_cmp_eq_u32 s59, 7
    s_cselect_b32 s59, 0, s59
    ds_read_b128 v[220:223], v22 offset:0
    ds_read_b128 v[224:227], v22 offset:1024
    ds_read_b128 v[228:231], v22 offset:2048
    ds_read_b128 v[232:235], v22 offset:3072
    s_lshl_b32 s51, s59, 12
    v_add_u32 v22, s51, v16
    s_add_u32 s59, s59, 1
    s_cmp_eq_u32 s59, 7
    s_cselect_b32 s59, 0, s59
    ds_read_b128 v[236:239], v22 offset:0
    ds_read_b128 v[240:243], v22 offset:1024
    ds_read_b128 v[244:247], v22 offset:2048
    ds_read_b128 v[248:251], v22 offset:3072
P5W_sequential_preLN__softmax_full_mha__glu_gated_reglu__prompt_kernel_55:
    v_lshrrev_b32 v22, 5, v1
    v_and_b32 v23, 31, v1
    v_lshlrev_b32 v24, 10, v22
    v_lshl_add_u32 v24, v23, 4, v24
    v_mul_u32_u24 v25, 896, v23
    v_lshl_add_u32 v25, v22, 5, v25
    s_lshl_b32 s51, s48, 1
    s_lshr_b32 s52, s29, 1
    s_add_u32 s51, s51, s52
    s_lshl_b32 s52, s49, 3
    s_lshl_b32 s53, s50, 2
    s_add_u32 s52, s52, s53
    s_and_b32 s53, s29, 1
    s_add_u32 s52, s52, s53
    s_mul_i32 s53, s51, 28672
    s_lshl_b32 s54, s52, 9
    s_add_u32 s62, s53, s54
    s_add_u32 s62, s62, 8388608
    s_mul_i32 s63, s51, 28672
    s_lshl_b32 s52, s52, 4
    s_add_u32 s63, s63, s52
    s_mov_b32 s44, s18
    s_mov_b32 s45, s19
    s_mov_b32 s46, 1835008
    s_mov_b32 s47, 0x20000
    s_lshl_b32 s57, s48, 1
    s_add_u32 s57, s57, s50
    s_lshl_b32 s57, s57, 2
    s_add_u32 s57, s57, s29
    s_mul_i32 s57, s57, 28672
    s_add_u32 s57, s57, 10223616
    s_add_u32 s61, s57, 4096
    s_lshl_b32 s58, s29, 1
    s_add_u32 s58, s58, s50
    s_mul_i32 s58, s58, 4096
    s_add_u32 s58, s58, 0
    s_lshr_b32 s51, s29, 1
    s_xor_b32 s51, s51, 0
    s_lshl_b32 s52, s29, 1
    s_add_u32 s51, s51, s52
    s_mul_i32 s51, s51, 4096
    s_add_u32 s51, s51, 0
    v_add_u32 v18, s51, v2
    v_add_u32 v20, 65536, v18
    s_lshr_b32 s51, s29, 1
    s_xor_b32 s51, s51, 1
    s_lshl_b32 s52, s29, 1
    s_add_u32 s51, s51, s52
    s_mul_i32 s51, s51, 4096
    s_add_u32 s51, s51, 0
    v_add_u32 v19, s51, v2
    v_add_u32 v21, 65536, v19
    s_xor_b32 s51, s28, 0
    s_mul_i32 s51, s51, 6144
    s_add_u32 s51, s51, 98304
    v_add_u32 v124, s51, v2
    s_xor_b32 s51, s28, 1
    s_mul_i32 s51, s51, 6144
    s_add_u32 s51, s51, 98304
    v_add_u32 v125, s51, v2
    s_xor_b32 s51, s28, 2
    s_mul_i32 s51, s51, 6144
    s_add_u32 s51, s51, 100352
    v_add_u32 v126, s51, v2
    s_xor_b32 s51, s28, 3
    s_mul_i32 s51, s51, 6144
    s_add_u32 s51, s51, 102400
    v_add_u32 v127, s51, v2
    s_waitcnt lgkmcnt(0)
    s_cmp_lg_u32 s28, 4
    s_cbranch_scc1 W35_sequential_preLN__softmax_full_mha__glu_gated_reglu__prompt_kernel_57
    s_lshl_b32 s35, s48, 3
    s_add_u32 s35, s35, s49
    s_lshl_b32 s35, s35, 7
    s_add_u32 s35, s35, 23658496
    v_lshlrev_b32 v6, 3, v1
    s_mov_b32 s34, 0
    s_mov_b64 exec, 0xffff
PL_sequential_preLN__softmax_full_mha__glu_gated_reglu__prompt_kernel_58:
    buffer_load_dwordx2 v[8:9], v6, s[24:27], s35 offen sc1
    s_add_u32 s34, s34, 1
    s_cmp_gt_u32 s34, 65536
    s_cbranch_scc1 PL_sequential_preLN__softmax_full_mha__glu_gated_reglu__prompt_kernel_59
    s_waitcnt vmcnt(0)
    v_cmp_ne_u64 vcc, v[8:9], v[4:5]
    s_nop 1
    s_cbranch_vccnz PL_sequential_preLN__softmax_full_mha__glu_gated_reglu__prompt_kernel_58
PL_sequential_preLN__softmax_full_mha__glu_gated_reglu__prompt_kernel_59:
    s_mov_b64 exec, -1
W35_sequential_preLN__softmax_full_mha__glu_gated_reglu__prompt_kernel_57:
    s_barrier
    s_add_u32 m0, s58, 0
    s_add_u32 s60, s57, 0
    buffer_load_dwordx4 v2, s[24:27], s60 offen offset:0 sc1 lds
    buffer_load_dwordx4 v2, s[24:27], s60 offen offset:1024 sc1 lds
    buffer_load_dwordx4 v2, s[24:27], s60 offen offset:2048 sc1 lds
    buffer_load_dwordx4 v2, s[24:27], s60 offen offset:3072 sc1 lds
    s_add_u32 m0, s58, 32768
    s_add_u32 s60, s57, 4096
    buffer_load_dwordx4 v2, s[24:27], s60 offen offset:0 sc1 lds
    buffer_load_dwordx4 v2, s[24:27], s60 offen offset:1024 sc1 lds
    buffer_load_dwordx4 v2, s[24:27], s60 offen offset:2048 sc1 lds
    buffer_load_dwordx4 v2, s[24:27], s60 offen offset:3072 sc1 lds
    s_add_u32 m0, s58, 65536
    s_add_u32 s60, s57, 8192
    buffer_load_dwordx4 v2, s[24:27], s60 offen offset:0 sc1 lds
    buffer_load_dwordx4 v2, s[24:27], s60 offen offset:1024 sc1 lds
    buffer_load_dwordx4 v2, s[24:27], s60 offen offset:2048 sc1 lds
    buffer_load_dwordx4 v2, s[24:27], s60 offen offset:3072 sc1 lds
    s_add_u32 m0, s58, 98304
    s_add_u32 s60, s57, 12288
    buffer_load_dwordx4 v2, s[24:27], s60 offen offset:0 sc1 lds
    buffer_load_dwordx4 v2, s[24:27], s60 offen offset:1024 sc1 lds
    buffer_load_dwordx4 v2, s[24:27], s60 offen offset:2048 sc1 lds
    buffer_load_dwordx4 v2, s[24:27], s60 offen offset:3072 sc1 lds
    s_waitcnt vmcnt(12)
    s_barrier
    ds_read_b128 v[60:63], v18 offset:0
    ds_read_b128 v[64:67], v19 offset:0
    ds_read_b128 v[68:71], v18 offset:1024
    ds_read_b128 v[72:75], v19 offset:1024
    ds_read_b128 v[76:79], v18 offset:2048
    ds_read_b128 v[80:83], v19 offset:2048
    ds_read_b128 v[84:87], v18 offset:3072
    ds_read_b128 v[88:91], v19 offset:3072
    s_waitcnt vmcnt(8)
    s_waitcnt lgkmcnt(0)
    s_barrier
    v_mfma_f32_32x32x16_bf16 v[28:43], v[140:143], v[60:63], 0
    s_add_u32 m0, s58, 0
    s_add_u32 s60, s57, 16384
    buffer_load_dwordx4 v2, s[24:27], s60 offen offset:0 sc1 lds
    ds_read_b128 v[92:95], v18 offset:32768
    v_mfma_f32_32x32x16_bf16 v[44:59], v[140:143], v[64:67], 0
    ds_read_b128 v[96:99], v19 offset:32768
    buffer_load_dwordx4 v2, s[24:27], s60 offen offset:1024 sc1 lds
    v_mfma_f32_32x32x16_bf16 v[28:43], v[144:147], v[68:71], v[28:43]
    ds_read_b128 v[100:103], v18 offset:33792
    ds_read_b128 v[104:107], v19 offset:33792
    v_mfma_f32_32x32x16_bf16 v[44:59], v[144:147], v[72:75], v[44:59]
    buffer_load_dwordx4 v2, s[24:27], s60 offen offset:2048 sc1 lds
    ds_read_b128 v[108:111], v18 offset:34816
    v_mfma_f32_32x32x16_bf16 v[28:43], v[148:151], v[76:79], v[28:43]
    ds_read_b128 v[112:115], v19 offset:34816
    v_mfma_f32_32x32x16_bf16 v[44:59], v[148:151], v[80:83], v[44:59]
    buffer_load_dwordx4 v2, s[24:27], s60 offen offset:3072 sc1 lds
    v_mfma_f32_32x32x16_bf16 v[28:43], v[152:155], v[84:87], v[28:43]
    ds_read_b128 v[116:119], v18 offset:35840
    v_mfma_f32_32x32x16_bf16 v[44:59], v[152:155], v[88:91], v[44:59]
    ds_read_b128 v[120:123], v19 offset:35840
    s_waitcnt vmcnt(8)
    s_waitcnt lgkmcnt(0)
    s_barrier
    v_mfma_f32_32x32x16_bf16 v[28:43], v[156:159], v[92:95], v[28:43]
    s_add_u32 m0, s58, 32768
    s_add_u32 s60, s57, 20480
    buffer_load_dwordx4 v2, s[24:27], s60 offen offset:0 sc1 lds
    ds_read_b128 v[60:63], v20 offset:0
    v_mfma_f32_32x32x16_bf16 v[44:59], v[156:159], v[96:99], v[44:59]
    ds_read_b128 v[64:67], v21 offset:0
    buffer_load_dwordx4 v2, s[24:27], s60 offen offset:1024 sc1 lds
    v_mfma_f32_32x32x16_bf16 v[28:43], v[160:163], v[100:103], v[28:43]
    ds_read_b128 v[68:71], v20 offset:1024
    ds_read_b128 v[72:75], v21 offset:1024
    v_mfma_f32_32x32x16_bf16 v[44:59], v[160:163], v[104:107], v[44:59]
    buffer_load_dwordx4 v2, s[24:27], s60 offen offset:2048 sc1 lds
    ds_read_b128 v[76:79], v20 offset:2048
    v_mfma_f32_32x32x16_bf16 v[28:43], v[164:167], v[108:111], v[28:43]
    ds_read_b128 v[80:83], v21 offset:2048
    v_mfma_f32_32x32x16_bf16 v[44:59], v[164:167], v[112:115], v[44:59]
    buffer_load_dwordx4 v2, s[24:27], s60 offen offset:3072 sc1 lds
    v_mfma_f32_32x32x16_bf16 v[28:43], v[168:171], v[116:119], v[28:43]
    ds_read_b128 v[84:87], v20 offset:3072
    v_mfma_f32_32x32x16_bf16 v[44:59], v[168:171], v[120:123], v[44:59]
    ds_read_b128 v[88:91], v21 offset:3072
    s_waitcnt vmcnt(8)
    s_waitcnt lgkmcnt(0)
    s_barrier
    v_mfma_f32_32x32x16_bf16 v[28:43], v[172:175], v[60:63], v[28:43]
    s_add_u32 m0, s58, 65536
    s_add_u32 s60, s57, 24576
    buffer_load_dwordx4 v2, s[24:27], s60 offen offset:0 sc1 lds
    ds_read_b128 v[92:95], v20 offset:32768
    v_mfma_f32_32x32x16_bf16 v[44:59], v[172:175], v[64:67], v[44:59]
    ds_read_b128 v[96:99], v21 offset:32768
    buffer_load_dwordx4 v2, s[24:27], s60 offen offset:1024 sc1 lds
    v_mfma_f32_32x32x16_bf16 v[28:43], v[176:179], v[68:71], v[28:43]
    ds_read_b128 v[100:103], v20 offset:33792
    ds_read_b128 v[104:107], v21 offset:33792
    v_mfma_f32_32x32x16_bf16 v[44:59], v[176:179], v[72:75], v[44:59]
    buffer_load_dwordx4 v2, s[24:27], s60 offen offset:2048 sc1 lds
    ds_read_b128 v[108:111], v20 offset:34816
    v_mfma_f32_32x32x16_bf16 v[28:43], v[180:183], v[76:79], v[28:43]
    ds_read_b128 v[112:115], v21 offset:34816
    v_mfma_f32_32x32x16_bf16 v[44:59], v[180:183], v[80:83], v[44:59]
    buffer_load_dwordx4 v2, s[24:27], s60 offen offset:3072 sc1 lds
    v_mfma_f32_32x32x16_bf16 v[28:43], v[184:187], v[84:87], v[28:43]
    ds_read_b128 v[116:119], v20 offset:35840
    v_mfma_f32_32x32x16_bf16 v[44:59], v[184:187], v[88:91], v[44:59]
    ds_read_b128 v[120:123], v21 offset:35840
    s_waitcnt vmcnt(8)
    s_waitcnt lgkmcnt(0)
    s_barrier
    v_mfma_f32_32x32x16_bf16 v[28:43], v[188:191], v[92:95], v[28:43]
    ds_read_b128 v[60:63], v18 offset:0
    v_mfma_f32_32x32x16_bf16 v[44:59], v[188:191], v[96:99], v[44:59]
    ds_read_b128 v[64:67], v19 offset:0
    v_mfma_f32_32x32x16_bf16 v[28:43], v[192:195], v[100:103], v[28:43]
    ds_read_b128 v[68:71], v18 offset:1024
    v_mfma_f32_32x32x16_bf16 v[44:59], v[192:195], v[104:107], v[44:59]
    ds_read_b128 v[72:75], v19 offset:1024
    v_mfma_f32_32x32x16_bf16 v[28:43], v[196:199], v[108:111], v[28:43]
    ds_read_b128 v[76:79], v18 offset:2048
    v_mfma_f32_32x32x16_bf16 v[44:59], v[196:199], v[112:115], v[44:59]
    ds_read_b128 v[80:83], v19 offset:2048
    v_mfma_f32_32x32x16_bf16 v[28:43], v[200:203], v[116:119], v[28:43]
    ds_read_b128 v[84:87], v18 offset:3072
    v_mfma_f32_32x32x16_bf16 v[44:59], v[200:203], v[120:123], v[44:59]
    ds_read_b128 v[88:91], v19 offset:3072
    s_waitcnt vmcnt(4)
    s_waitcnt lgkmcnt(0)
    s_barrier
    v_mfma_f32_32x32x16_bf16 v[28:43], v[204:207], v[60:63], v[28:43]
    ds_read_b128 v[92:95], v18 offset:32768
    v_mfma_f32_32x32x16_bf16 v[44:59], v[204:207], v[64:67], v[44:59]
    ds_read_b128 v[96:99], v19 offset:32768
    v_mfma_f32_32x32x16_bf16 v[28:43], v[208:211], v[68:71], v[28:43]
    ds_read_b128 v[100:103], v18 offset:33792
    v_mfma_f32_32x32x16_bf16 v[44:59], v[208:211], v[72:75], v[44:59]
    ds_read_b128 v[104:107], v19 offset:33792
    v_mfma_f32_32x32x16_bf16 v[28:43], v[212:215], v[76:79], v[28:43]
    ds_read_b128 v[108:111], v18 offset:34816
    v_mfma_f32_32x32x16_bf16 v[44:59], v[212:215], v[80:83], v[44:59]
    ds_read_b128 v[112:115], v19 offset:34816
    v_mfma_f32_32x32x16_bf16 v[28:43], v[216:219], v[84:87], v[28:43]
    ds_read_b128 v[116:119], v18 offset:35840
    v_mfma_f32_32x32x16_bf16 v[44:59], v[216:219], v[88:91], v[44:59]
    ds_read_b128 v[120:123], v19 offset:35840
    s_waitcnt vmcnt(0)
    s_waitcnt lgkmcnt(0)
    s_barrier
    v_mfma_f32_32x32x16_bf16 v[28:43], v[220:223], v[92:95], v[28:43]
    ds_read_b128 v[60:63], v20 offset:0
    v_mfma_f32_32x32x16_bf16 v[44:59], v[220:223], v[96:99], v[44:59]
    ds_read_b128 v[64:67], v21 offset:0
    v_mfma_f32_32x32x16_bf16 v[28:43], v[224:227], v[100:103], v[28:43]
    ds_read_b128 v[68:71], v20 offset:1024
    v_mfma_f32_32x32x16_bf16 v[44:59], v[224:227], v[104:107], v[44:59]
    ds_read_b128 v[72:75], v21 offset:1024
    v_mfma_f32_32x32x16_bf16 v[28:43], v[228:231], v[108:111], v[28:43]
    ds_read_b128 v[76:79], v20 offset:2048
    v_mfma_f32_32x32x16_bf16 v[44:59], v[228:231], v[112:115], v[44:59]
    ds_read_b128 v[80:83], v21 offset:2048
    v_mfma_f32_32x32x16_bf16 v[28:43], v[232:235], v[116:119], v[28:43]
    ds_read_b128 v[84:87], v20 offset:3072
    v_mfma_f32_32x32x16_bf16 v[44:59], v[232:235], v[120:123], v[44:59]
    ds_read_b128 v[88:91], v21 offset:3072
    s_waitcnt lgkmcnt(6)
    v_mfma_f32_32x32x16_bf16 v[28:43], v[236:239], v[60:63], v[28:43]
    v_mfma_f32_32x32x16_bf16 v[44:59], v[236:239], v[64:67], v[44:59]
    s_waitcnt lgkmcnt(4)
    v_mfma_f32_32x32x16_bf16 v[28:43], v[240:243], v[68:71], v[28:43]
    v_mfma_f32_32x32x16_bf16 v[44:59], v[240:243], v[72:75], v[44:59]
    s_waitcnt lgkmcnt(2)
    v_mfma_f32_32x32x16_bf16 v[28:43], v[244:247], v[76:79], v[28:43]
    v_mfma_f32_32x32x16_bf16 v[44:59], v[244:247], v[80:83], v[44:59]
    s_waitcnt lgkmcnt(0)
    v_mfma_f32_32x32x16_bf16 v[28:43], v[248:251], v[84:87], v[28:43]
    v_mfma_f32_32x32x16_bf16 v[44:59], v[248:251], v[88:91], v[44:59]
    v_lshlrev_b32 v84, 16, v12
    v_and_b32 v85, 0xffff0000, v12
    v_lshlrev_b32 v86, 16, v13
    v_and_b32 v87, 0xffff0000, v13
    v_lshlrev_b32 v88, 16, v14
    v_and_b32 v89, 0xffff0000, v14
    v_lshlrev_b32 v90, 16, v15
    v_and_b32 v91, 0xffff0000, v15
    s_nop 2
    ds_write_b128 v125, v[36:39]
    ds_write_b128 v125, v[40:43] offset:1024
    ds_write_b128 v126, v[44:47]
    ds_write_b128 v126, v[48:51] offset:1024
    ds_write_b128 v127, v[52:55]
    ds_write_b128 v127, v[56:59] offset:1024
    v_add_f32 v28, v28, v84
    v_add_f32 v29, v29, v85
    v_add_f32 v30, v30, v86
    v_add_f32 v31, v31, v87
    v_add_f32 v32, v32, v88
    v_add_f32 v33, v33, v89
    v_add_f32 v34, v34, v90
    v_add_f32 v35, v35, v91
    s_waitcnt lgkmcnt(0)
    s_barrier
    ds_read_b128 v[60:63], v124 offset:0
    ds_read_b128 v[64:67], v124 offset:1024
    ds_read_b128 v[68:71], v124 offset:2048
    ds_read_b128 v[72:75], v124 offset:3072
    ds_read_b128 v[76:79], v124 offset:4096
    ds_read_b128 v[80:83], v124 offset:5120
    s_waitcnt lgkmcnt(4)
    v_add_f32 v28, v28, v60
    v_add_f32 v29, v29, v61
    v_add_f32 v30, v30, v62
    v_add_f32 v31, v31, v63
    v_add_f32 v32, v32, v64
    v_add_f32 v33, v33, v65
    v_add_f32 v34, v34, v66
    v_add_f32 v35, v35, v67
    s_waitcnt lgkmcnt(2)
    v_add_f32 v28, v28, v68
    v_add_f32 v29, v29, v69
    v_add_f32 v30, v30, v70
    v_add_f32 v31, v31, v71
    v_add_f32 v32, v32, v72
    v_add_f32 v33, v33, v73
    v_add_f32 v34, v34, v74
    v_add_f32 v35, v35, v75
    s_waitcnt lgkmcnt(0)
    v_add_f32 v28, v28, v76
    v_add_f32 v29, v29, v77
    v_add_f32 v30, v30, v78
    v_add_f32 v31, v31, v79
    v_add_f32 v32, v32, v80
    v_add_f32 v33, v33, v81
    v_add_f32 v34, v34, v82
    v_add_f32 v35, v35, v83
    v_cvt_pk_bf16_f32 v12, v28, v29
    v_cvt_pk_bf16_f32 v13, v30, v31
    v_cvt_pk_bf16_f32 v14, v32, v33
    v_cvt_pk_bf16_f32 v15, v34, v35
    buffer_store_dwordx4 v[12:15], v25, s[44:47], s63 offen
P35X_sequential_preLN__softmax_full_mha__glu_gated_reglu__prompt_kernel_53:
    s_or_b32 s34, s2, s28
    s_cmp_lg_u32 s34, 0
    s_cbranch_scc1 ZD_sequential_preLN__softmax_full_mha__glu_gated_reglu__prompt_kernel_60
    v_mov_b32 v6, 0
    v_mov_b32 v7, 0
    s_mov_b64 exec, 1
    global_store_dwordx2 v6, v[6:7], s[20:21] sc1
    s_mov_b64 exec, -1
ZD_sequential_preLN__softmax_full_mha__glu_gated_reglu__prompt_kernel_60:
END_sequential_preLN__softmax_full_mha__glu_gated_reglu__prompt_kernel_1:
    s_endpgm
SLOW_sequential_preLN__softmax_full_mha__glu_gated_reglu__prompt_kernel_34:
    s_waitcnt vmcnt(0) lgkmcnt(0)
    s_mov_b32 s56, 1
    v_cndmask_b32 v22, v22, v136, s[30:31]
    v_cndmask_b32 v23, v23, v136, s[30:31]
    v_cndmask_b32 v30, v30, v136, s[30:31]
    v_cndmask_b32 v31, v31, v136, s[30:31]
    v_mov_b32 v132, 0xff800000
    v_mov_b32 v133, 0xff800000
    s_mov_b32 s52, s57
    s_mov_b32 s55, 0
MX_sequential_preLN__softmax_full_mha__glu_gated_reglu__prompt_kernel_61:
    s_barrier
    s_mov_b32 s46, 0
    s_add_u32 m0, s54, s46
    s_add_u32 s46, s46, 32768
    buffer_load_dwordx4 v2, s[24:27], s52 offen sc1 lds
    buffer_load_dwordx4 v2, s[24:27], s52 offen offset:1024 sc1 lds
    s_add_u32 s52, s52, 4096
    s_add_u32 m0, s54, s46
    s_add_u32 s46, s46, 32768
    buffer_load_dwordx4 v2, s[24:27], s52 offen sc1 lds
    buffer_load_dwordx4 v2, s[24:27], s52 offen offset:1024 sc1 lds
    s_add_u32 s52, s52, 4096
    s_add_u32 m0, s54, s46
    s_add_u32 s46, s46, 32768
    buffer_load_dwordx4 v2, s[24:27], s52 offen sc1 lds
    buffer_load_dwordx4 v2, s[24:27], s52 offen offset:1024 sc1 lds
    s_add_u32 s52, s52, 4096
    s_add_u32 m0, s54, s46
    s_add_u32 s46, s46, 32768
    buffer_load_dwordx4 v2, s[24:27], s52 offen sc1 lds
    buffer_load_dwordx4 v2, s[24:27], s52 offen offset:1024 sc1 lds
    s_add_u32 s52, s52, 4096
    v_mov_b32 v36, v32
    s_mov_b32 s47, 0
    s_waitcnt vmcnt(0)
    s_barrier
MX_sequential_preLN__softmax_full_mha__glu_gated_reglu__prompt_kernel_62:
    ds_read_b128 v[108:111], v36 offset:0
    ds_read_b128 v[112:115], v36 offset:1024
    s_waitcnt lgkmcnt(0)
    v_mfma_f32_32x32x16_bf16 v[44:59], v[108:111], v[16:19], 0
    v_mfma_f32_32x32x16_bf16 v[44:59], v[112:115], v[20:23], v[44:59]
    v_mfma_f32_32x32x16_bf16 v[60:75], v[108:111], v[24:27], 0
    v_mfma_f32_32x32x16_bf16 v[60:75], v[112:115], v[28:31], v[60:75]
    s_nop 11
    v_max3_f32 v132, v132, v44, v45
    v_max3_f32 v132, v132, v46, v47
    v_max3_f32 v132, v132, v48, v49
    v_max3_f32 v132, v132, v50, v51
    v_max3_f32 v132, v132, v52, v53
    v_max3_f32 v132, v132, v54, v55
    v_max3_f32 v132, v132, v56, v57
    v_max3_f32 v132, v132, v58, v59
    v_max3_f32 v133, v133, v60, v61
    v_max3_f32 v133, v133, v62, v63
    v_max3_f32 v133, v133, v64, v65
    v_max3_f32 v133, v133, v66, v67
    v_max3_f32 v133, v133, v68, v69
    v_max3_f32 v133, v133, v70, v71
    v_max3_f32 v133, v133, v72, v73
    v_max3_f32 v133, v133, v74, v75
    ds_read_b128 v[108:111], v36 offset:4096
    ds_read_b128 v[112:115], v36 offset:5120
    s_waitcnt lgkmcnt(0)
    v_mfma_f32_32x32x16_bf16 v[44:59], v[108:111], v[16:19], 0
    v_mfma_f32_32x32x16_bf16 v[44:59], v[112:115], v[20:23], v[44:59]
    v_mfma_f32_32x32x16_bf16 v[60:75], v[108:111], v[24:27], 0
    v_mfma_f32_32x32x16_bf16 v[60:75], v[112:115], v[28:31], v[60:75]
    s_nop 11
    v_max3_f32 v132, v132, v44, v45
    v_max3_f32 v132, v132, v46, v47
    v_max3_f32 v132, v132, v48, v49
    v_max3_f32 v132, v132, v50, v51
    v_max3_f32 v132, v132, v52, v53
    v_max3_f32 v132, v132, v54, v55
    v_max3_f32 v132, v132, v56, v57
    v_max3_f32 v132, v132, v58, v59
    v_max3_f32 v133, v133, v60, v61
    v_max3_f32 v133, v133, v62, v63
    v_max3_f32 v133, v133, v64, v65
    v_max3_f32 v133, v133, v66, v67
    v_max3_f32 v133, v133, v68, v69
    v_max3_f32 v133, v133, v70, v71
    v_max3_f32 v133, v133, v72, v73
    v_max3_f32 v133, v133, v74, v75
    v_add_u32 v36, 32768, v36
    s_add_u32 s47, s47, 1
    s_cmp_lt_u32 s47, 4
    s_cbranch_scc1 MX_sequential_preLN__softmax_full_mha__glu_gated_reglu__prompt_kernel_62
    s_add_u32 s55, s55, 1
    s_cmp_lt_u32 s55, 2
    s_cbranch_scc1 MX_sequential_preLN__softmax_full_mha__glu_gated_reglu__prompt_kernel_61
    v_mov_b32 v134, v132
    s_nop 1
    v_permlane32_swap_b32 v132, v134
    v_max_f32 v132, v132, v134
    v_mov_b32 v134, v133
    s_nop 1
    v_permlane32_swap_b32 v133, v134
    v_max_f32 v133, v133, v134
    s_barrier
    ds_write_b32 v37, v132
    ds_write_b32 v37, v133 offset:4
    s_waitcnt lgkmcnt(0)
    s_barrier
    v_subrev_u32 v134, 0, v38
    ds_read_b64 v[46:47], v134
    v_subrev_u32 v134, 2048, v39
    ds_read_b64 v[48:49], v134
    v_subrev_u32 v134, 4096, v40
    ds_read_b64 v[50:51], v134
    s_waitcnt lgkmcnt(0)
    v_max_f32 v132, v132, v46
    v_max_f32 v133, v133, v47
    v_max_f32 v132, v132, v49
    v_max_f32 v133, v133, v48
    v_max_f32 v132, v132, v51
    v_max_f32 v133, v133, v50
    v_sub_f32 v132, 0, v132
    v_cvt_pk_bf16_f32 v134, v132, v132
    v_lshlrev_b32 v134, 16, v134
    v_sub_f32 v132, v132, v134
    v_cvt_pk_bf16_f32 v135, v134, v132
    v_cndmask_b32 v22, v22, v135, s[30:31]
    v_and_b32 v135, 0xffff0000, v135
    v_sub_f32 v132, v132, v135
    v_cvt_pk_bf16_f32 v135, v132, v136
    v_cndmask_b32 v23, v23, v135, s[30:31]
    v_sub_f32 v133, 0, v133
    v_cvt_pk_bf16_f32 v134, v133, v133
    v_lshlrev_b32 v134, 16, v134
    v_sub_f32 v133, v133, v134
    v_cvt_pk_bf16_f32 v135, v134, v133
    v_cndmask_b32 v30, v30, v135, s[30:31]
    v_and_b32 v135, 0xffff0000, v135
    v_sub_f32 v133, v133, v135
    v_cvt_pk_bf16_f32 v135, v133, v136
    v_cndmask_b32 v31, v31, v135, s[30:31]
    s_barrier
    v_mov_b32 v236, 0x40000000
    v_mov_b32 v237, 0x40000000
    v_mov_b32 v238, 0x40000000
    v_mov_b32 v244, 0x40000000
    v_mov_b32 v245, 0x40000000
    v_mov_b32 v239, v2
    s_add_u32 m0, s54, 0
    s_add_u32 s52, s57, 0
    buffer_load_dwordx4 v2, s[24:27], s52 offen offset:0 sc1 lds
    buffer_load_dwordx4 v2, s[24:27], s52 offen offset:1024 sc1 lds
    s_add_u32 m0, s54, 0
    s_add_u32 s53, s57, 2095104
    buffer_load_dwordx4 v2, s[24:27], s53 offen offset:2048 sc1 lds
    buffer_load_dwordx4 v2, s[24:27], s53 offen offset:3072 sc1 lds
    s_add_u32 m0, s54, 32768
    s_add_u32 s52, s57, 4096
    buffer_load_dwordx4 v2, s[24:27], s52 offen offset:0 sc1 lds
    buffer_load_dwordx4 v2, s[24:27], s52 offen offset:1024 sc1 lds
    s_add_u32 m0, s54, 32768
    s_add_u32 s53, s57, 2099200
    buffer_load_dwordx4 v2, s[24:27], s53 offen offset:2048 sc1 lds
    buffer_load_dwordx4 v2, s[24:27], s53 offen offset:3072 sc1 lds
    s_waitcnt vmcnt(4)
    s_barrier
    ds_read_b128 v[108:111], v32 offset:0
    ds_read_b128 v[112:115], v32 offset:1024
    s_branch MAIN_sequential_preLN__softmax_full_mha__glu_gated_reglu__prompt_kernel_22
CODE_END:
.section .rodata,"a"
.p2align 6
.amdhsa_kernel sequential_preLN__softmax_full_mha__glu_gated_reglu__prompt_kernel
  .amdhsa_next_free_vgpr 254
  .amdhsa_next_free_sgpr 97
  .amdhsa_accum_offset 256
  .amdhsa_group_segment_fixed_size 0
  .amdhsa_kernarg_size 80
  .amdhsa_user_sgpr_count 2
  .amdhsa_user_sgpr_kernarg_segment_ptr 1
  .amdhsa_system_sgpr_workgroup_id_x 1
.end_amdhsa_kernel
```
